```python
import torch

def _softmax(x, axis=-1):
    return torch.softmax(x, dim=axis)
def _gelu(x):
    return torch.nn.functional.gelu(x, approximate="tanh")
def _silu(x):
    return torch.nn.functional.silu(x)
def _sigmoid(x):
    return torch.sigmoid(x)
def _layernorm(x, axis=-1, eps=1e-5):
    m = x.mean(dim=axis, keepdim=True)
    v = x.var(dim=axis, keepdim=True, unbiased=False)
    return (x - m) / torch.sqrt(v + eps)
def _scatter_add(tgt, idx, src, axis=0):
    return tgt.clone().index_add_(axis, idx, src)
def _segment_sum(src, seg, n):
    out = torch.zeros((n,) + src.shape[1:], dtype=src.dtype)
    return out.index_add_(0, seg, src)
def _pad(x, pw):
    flat = tuple(v for pair in reversed(pw) for v in pair)
    return torch.nn.functional.pad(x, flat)

kernel_name = 'concat_heads__ssm_conv_h3__grouped_kv_mqa__prompt'

def setup_inputs():

    _w = (lambda a: (lambda t: t.to(torch.bfloat16) if t.is_floating_point() else t)(torch.as_tensor(a)))
    def _A_setup():
        B, S, D = 1, 2048, 448
        ks = 4
        return {
            "q": _w((lambda *s: torch.randn(*s, dtype=torch.bfloat16) * 0.05)(B, S, D)),
            "k": _w((lambda *s: torch.randn(*s, dtype=torch.bfloat16) * 0.2)(B, S, D)),
            "v": _w((lambda *s: torch.randn(*s, dtype=torch.bfloat16) * 0.2)(B, S, D)),
            "shift_k": _w((lambda *s: torch.randn(*s, dtype=torch.bfloat16) * 0.2)(D, ks) * 0.5),
            "ssm_k": _w((lambda *s: torch.randn(*s, dtype=torch.bfloat16) * 0.4)(D, S) * (1.0 / S ** 0.5)),
            "ssm_D": _w((lambda *s: torch.randn(*s, dtype=torch.bfloat16) * 0.2)(D)),
        }
    _A_in = _A_setup()

    def _B_setup():
        B, S, D, H = 1, 2048, 448, 16
        Dh = D // H
        return {
            "x": _w((lambda *s: torch.randn(*s, dtype=torch.bfloat16) * 0.05)(B, S, D)),
            "wq": _w((lambda *s: torch.randn(*s, dtype=torch.bfloat16) * 0.8)(D, H * Dh)),
            "wk": _w((lambda *s: torch.randn(*s, dtype=torch.bfloat16) * 0.8)(D, Dh)),
            "wv": _w((lambda *s: torch.randn(*s, dtype=torch.bfloat16) * 0.05)(D, Dh)),
            "wo": _w((lambda *s: torch.randn(*s, dtype=torch.bfloat16) * 0.05)(H * Dh, D)),
        }
    _B_in = _B_setup()

    return {
        "A_q": _A_in["q"],
        "A_k": _A_in["k"],
        "A_v": _A_in["v"],
        "A_shift_k": _A_in["shift_k"],
        "A_ssm_k": _A_in["ssm_k"],
        "A_ssm_D": _A_in["ssm_D"],
        "B_x": _B_in["x"],
        "B_wq": _B_in["wq"],
        "B_wk": _B_in["wk"],
        "B_wv": _B_in["wv"],
        "B_wo": _B_in["wo"],
    }

def reference(A_q, A_k, A_v, A_shift_k, A_ssm_k, A_ssm_D, B_x, B_wq, B_wk, B_wv, B_wo):
    def _A_ref(q, k, v, shift_k, ssm_k, ssm_D):
        B, S, D = q.shape
        ks = shift_k.shape[-1]
        k_pad = _pad(k, ((0, 0), (ks - 1, 0), (0, 0)))
        k_shift = torch.zeros_like(k)
        for t in range(ks):
            k_shift = k_shift + k_pad[:, t:t + S, :] * shift_k[:, ks - 1 - t][None, None, :]
        kv = k_shift * v
        L = 2 * S
        kv_pad = _pad(kv, ((0, 0), (0, S), (0, 0)))
        kf_pad = _pad(ssm_k, ((0, 0), (0, S)))
        kv_f = (lambda x, axes=(-2,-1): torch.fft.rfft2(x.float(), dim=axes))(kv_pad[:, None, :, :], axes=(1, 2))
        kf_f = (lambda x, axes=(-2,-1): torch.fft.rfft2(x.float(), dim=axes))(kf_pad[:, None, :], axes=(1, 2))
        kf_f = (lambda x, *d: x.permute(*d))(kf_f, 1, 2, 0)
        y_f = kv_f * kf_f[None, :, :, :]
        y = (lambda x, s, axes=(-2,-1): torch.fft.irfft2(x, s=s, dim=axes).to(torch.bfloat16))(y_f, (1, L), axes=(1, 2))[:, 0, :S, :]
        y = y + kv * ssm_D[None, None, :]
        return q * y

    def _B_ref(x, wq, wk, wv, wo):
        B, S, D = x.shape
        H = 16
        Dh = D // H
        q = (lambda x, *d: x.permute(*d))((x @ wq).reshape(B, S, H, Dh), 0, 2, 1, 3)
        k = x @ wk
        v = x @ wv
        scores = torch.einsum("bhqd,bkd->bhqk", q, k) * (Dh ** -0.5)
        p = _softmax(scores, axis=-1)
        o = torch.einsum("bhqk,bkd->bhqd", p, v)
        return (lambda x, *d: x.permute(*d))(o, 0, 2, 1, 3).reshape(B, S, H * Dh) @ wo

    a = _A_ref(A_q, A_k, A_v, A_shift_k, A_ssm_k, A_ssm_D)
    b = _B_ref(B_x, B_wq, B_wk, B_wv, B_wo)
    return torch.concatenate([a, b], axis=-1)
```

```asm
; @launch grid=(256,1,1) block=(768,1,1) lds=161280
.amdgcn_target "amdgcn-amd-amdhsa--gfx950"
.text
.globl concat_heads__ssm_conv_h3__grouped_kv_mqa__prompt_kernel
.p2align 8
.type concat_heads__ssm_conv_h3__grouped_kv_mqa__prompt_kernel,@function
concat_heads__ssm_conv_h3__grouped_kv_mqa__prompt_kernel:
    s_cmp_ge_u32 s2, 256
    s_cbranch_scc1 L_END
    s_load_dwordx16 s[28:43], s[0:1], 48
    v_cmp_gt_u32 vcc, 8, v0
    s_getpc_b64 s[8:9]
L_PC:
    s_lshr_b32 s10, s2, 3
    s_lshl_b32 s10, s10, 10
    s_and_saveexec_b64 s[12:13], vcc
    s_cbranch_execz L_NOPF
    v_lshl_add_u32 v1, v0, 7, s10
    v_min_u32 v1, L_END - L_PC, v1
    global_load_dword v140, v1, s[8:9]
L_NOPF:
    s_mov_b64 exec, -1
    v_lshrrev_b32 v1, 6, v0
    v_and_b32 v0, 63, v0
    s_and_b32 s4, s2, 31
    v_readfirstlane_b32 s3, v1
    s_lshr_b32 s5, s2, 5
    v_lshlrev_b32 v1, 4, v0
    v_mov_b32 v2, 0
    v_mov_b32 v21, 160768
    v_lshl_add_u32 v3, v0, 2, v21
    ds_write_b32 v3, v2
    v_lshrrev_b32 v4, 3, v0
    v_mul_u32_u24 v4, 896, v4
    v_and_b32 v5, 7, v0
    v_lshrrev_b32 v6, 4, v0
    v_xor_b32 v7, v5, v6
    v_lshl_add_u32 v8, v7, 4, v4
    v_xor_b32 v9, 64, v8
    v_and_b32 v6, 1, v6
    v_lshlrev_b32 v6, 2, v6
    v_xor_b32 v7, v5, v6
    v_lshl_add_u32 v10, v7, 4, v4
    s_and_b32 s13, s5, 1
    s_mul_i32 s14, s4, 57344
    s_lshl_b32 s70, s3, 7
    s_add_u32 s14, s14, s70
    s_mul_i32 s68, s13, 28672
    s_add_u32 s68, s68, s14
    s_lshl_b32 s72, s3, 13
    s_lshl_b32 s69, s13, 12
    s_add_u32 s69, s69, s72
    s_mul_i32 s74, s3, 3584
    s_lshr_b32 s73, s4, 3
    s_lshl_b32 s73, s73, 1
    v_mov_b32 v3, 1
    s_mul_i32 s71, s3, 57344
    s_mul_i32 s70, s5, 112
    s_add_u32 s71, s71, s70
    s_add_u32 s72, s72, 57344
    s_mov_b32 s50, 1835008
    s_mov_b32 s51, 0x20000
    s_mov_b32 s54, 401408
    s_mov_b32 s55, 0x20000
    s_mov_b32 s58, 25088
    s_mov_b32 s59, 0x20000
    s_cmp_ge_u32 s3, 7
    s_cbranch_scc1 L_W7
    s_setprio 2
    s_waitcnt lgkmcnt(0)
    s_mov_b32 s48, s28
    s_mov_b32 s49, s29
    s_add_u32 m0, s69, 0
    s_add_u32 s70, s68, 0
    buffer_load_dwordx4 v8, s[48:51], s70 offen  lds
    s_add_u32 m0, s69, 1024
    s_add_u32 s70, s68, 7168
    buffer_load_dwordx4 v9, s[48:51], s70 offen  lds
    s_add_u32 m0, s69, 2048
    s_add_u32 s70, s68, 14336
    buffer_load_dwordx4 v8, s[48:51], s70 offen  lds
    s_add_u32 m0, s69, 3072
    s_add_u32 s70, s68, 21504
    buffer_load_dwordx4 v9, s[48:51], s70 offen  lds
    s_barrier
    s_load_dwordx2 s[6:7], s[42:43], 0
    s_load_dwordx8 s[16:23], s[0:1], 0
    s_load_dwordx4 s[24:27], s[0:1], 32
    s_bitcmp1_b32 s5, 1
    s_cselect_b32 s56, s34, s32
    s_cselect_b32 s57, s35, s33
    s_mov_b32 s52, s30
    s_mov_b32 s53, s31
    s_cmp_ge_u32 s5, 4
    s_cbranch_scc1 L_LD_H
    s_branch L_LD_P
L_W7:
    s_waitcnt lgkmcnt(0)
    s_barrier
    s_load_dwordx2 s[6:7], s[42:43], 0
    s_load_dwordx8 s[16:23], s[0:1], 0
    s_load_dwordx4 s[24:27], s[0:1], 32
    s_branch L_W7B
L_LD_P:
    s_add_u32 m0, s74, 115712
    s_setprio 1
    buffer_load_dwordx4 v1, s[56:59], s74 offen offset:0 lds
    buffer_load_dwordx4 v1, s[56:59], s74 offen offset:1024 lds
    buffer_load_dwordx4 v1, s[56:59], s74 offen offset:2048 lds
    s_mov_b32 exec_hi, 1
    buffer_load_dwordx4 v1, s[56:59], s74 offen offset:3072 lds
    s_mov_b32 exec_hi, -1
    s_setprio 0
    s_mov_b32 exec_lo, 0xf7f77f7f
    s_mov_b32 exec_hi, 0xf7f77f7f
    s_lshl_b32 s70, s73, 10
    s_add_u32 m0, s72, s70
    s_mul_i32 s70, s73, 7168
    s_add_u32 s70, s70, s71
    buffer_load_dwordx4 v10, s[52:55], s70 offen  lds
    s_add_u32 s73, s73, 1
    s_and_b32 s73, s73, 7
    s_lshl_b32 s70, s73, 10
    s_add_u32 m0, s72, s70
    s_mul_i32 s70, s73, 7168
    s_add_u32 s70, s70, s71
    buffer_load_dwordx4 v10, s[52:55], s70 offen  lds
    s_add_u32 s73, s73, 1
    s_and_b32 s73, s73, 7
    s_mov_b64 exec, -1
    s_cmp_ge_u32 s3, 4
    s_cselect_b32 s70, 4, 0
    v_add_u32 v4, s70, v21
    s_waitcnt vmcnt(2)
    s_mov_b64 exec, 1
    ds_add_u32 v4, v3 offset:176
    s_mov_b64 exec, -1
    s_branch L_LD_Q
L_LD_H:
    s_setprio 0
    s_mov_b32 exec_lo, 0xf7f77f7f
    s_mov_b32 exec_hi, 0xf7f77f7f
    s_lshl_b32 s70, s73, 10
    s_add_u32 m0, s72, s70
    s_mul_i32 s70, s73, 7168
    s_add_u32 s70, s70, s71
    buffer_load_dwordx4 v10, s[52:55], s70 offen  lds
    s_add_u32 s73, s73, 1
    s_and_b32 s73, s73, 7
    s_lshl_b32 s70, s73, 10
    s_add_u32 m0, s72, s70
    s_mul_i32 s70, s73, 7168
    s_add_u32 s70, s70, s71
    buffer_load_dwordx4 v10, s[52:55], s70 offen  lds
    s_add_u32 s73, s73, 1
    s_and_b32 s73, s73, 7
    s_mov_b64 exec, -1
L_LD_Q:
    s_mov_b32 exec_lo, 0xf7f77f7f
    s_mov_b32 exec_hi, 0xf7f77f7f
    s_lshl_b32 s70, s73, 10
    s_add_u32 m0, s72, s70
    s_mul_i32 s70, s73, 7168
    s_add_u32 s70, s70, s71
    buffer_load_dwordx4 v10, s[52:55], s70 offen  lds
    s_add_u32 s73, s73, 1
    s_and_b32 s73, s73, 7
    s_lshl_b32 s70, s73, 10
    s_add_u32 m0, s72, s70
    s_mul_i32 s70, s73, 7168
    s_add_u32 s70, s70, s71
    buffer_load_dwordx4 v10, s[52:55], s70 offen  lds
    s_add_u32 s73, s73, 1
    s_and_b32 s73, s73, 7
    s_lshl_b32 s70, s73, 10
    s_add_u32 m0, s72, s70
    s_mul_i32 s70, s73, 7168
    s_add_u32 s70, s70, s71
    buffer_load_dwordx4 v10, s[52:55], s70 offen  lds
    s_add_u32 s73, s73, 1
    s_and_b32 s73, s73, 7
    s_lshl_b32 s70, s73, 10
    s_add_u32 m0, s72, s70
    s_mul_i32 s70, s73, 7168
    s_add_u32 s70, s70, s71
    buffer_load_dwordx4 v10, s[52:55], s70 offen  lds
    s_add_u32 s73, s73, 1
    s_and_b32 s73, s73, 7
    s_lshl_b32 s70, s73, 10
    s_add_u32 m0, s72, s70
    s_mul_i32 s70, s73, 7168
    s_add_u32 s70, s70, s71
    buffer_load_dwordx4 v10, s[52:55], s70 offen  lds
    s_add_u32 s73, s73, 1
    s_and_b32 s73, s73, 7
    s_lshl_b32 s70, s73, 10
    s_add_u32 m0, s72, s70
    s_mul_i32 s70, s73, 7168
    s_add_u32 s70, s70, s71
    buffer_load_dwordx4 v10, s[52:55], s70 offen  lds
    s_mov_b64 exec, -1
    s_xor_b32 s69, s69, 4096
    s_xor_b32 s13, s13, 1
    s_mul_i32 s68, s13, 28672
    s_add_u32 s68, s68, s14
    s_add_u32 m0, s69, 0
    s_add_u32 s70, s68, 0
    buffer_load_dwordx4 v8, s[48:51], s70 offen  lds
    s_add_u32 m0, s69, 1024
    s_add_u32 s70, s68, 7168
    buffer_load_dwordx4 v9, s[48:51], s70 offen  lds
    s_add_u32 m0, s69, 2048
    s_add_u32 s70, s68, 14336
    buffer_load_dwordx4 v8, s[48:51], s70 offen  lds
    s_add_u32 m0, s69, 3072
    s_add_u32 s70, s68, 21504
    buffer_load_dwordx4 v9, s[48:51], s70 offen  lds
    s_mov_b32 s44, s42
    s_mov_b32 s45, s43
    s_mov_b32 s46, 16777216
    s_mov_b32 s47, 0x20000
    s_and_b32 s8, s3, 1
    s_lshr_b32 s9, s3, 1
    s_and_b32 s10, s9, 1
    s_lshr_b32 s11, s9, 1
    s_lshl_b32 s12, s4, 1
    s_add_u32 s12, s12, s8
    s_lshl_b32 s12, s12, 4
    s_lshl_b32 s13, s5, 1
    s_add_u32 s12, s12, s13
    s_add_u32 s12, s12, s10
    s_lshl_b32 s12, s12, 1
    s_add_u32 s12, s12, s11
    s_lshl_b32 s12, s12, 10
    s_add_u32 s12, s12, 1048576
    s_waitcnt lgkmcnt(0)
    s_mul_i32 s6, s6, 0x9E3779B1
    s_add_u32 s6, s6, 0x7F4A7C15
    s_mul_i32 s7, s7, 0x85EBCA6B
    s_add_u32 s7, s7, 0xC2B2AE35
    s_lshr_b32 s13, s3, 1
    s_and_b32 s13, s13, 1
    v_and_b32 v4, 31, v0
    v_lshrrev_b32 v5, 5, v0
    v_bfe_u32 v6, v0, 1, 3
    v_xor_b32 v5, v5, v6
    v_lshlrev_b32 v5, 4, v5
    v_lshl_add_u32 v5, v4, 7, v5
    s_lshl_b32 s70, s13, 12
    v_add_u32 v16, s70, v5
    v_xor_b32 v17, 32, v16
    v_xor_b32 v18, 64, v16
    v_xor_b32 v19, 96, v16
    s_and_b32 s15, s3, 1
    s_mul_i32 s15, s15, 56
    v_bfe_u32 v4, v0, 4, 1
    v_lshlrev_b32 v4, 5, v4
    v_and_b32 v5, 3, v0
    v_lshl_add_u32 v4, v5, 3, v4
    v_add_u32 v4, s15, v4
    v_bfe_u32 v5, v0, 3, 1
    v_lshlrev_b32 v5, 6, v5
    v_xor_b32 v4, v4, v5
    v_lshrrev_b32 v5, 5, v0
    v_lshlrev_b32 v5, 3, v5
    v_bfe_u32 v6, v0, 2, 2
    v_add_u32 v5, v5, v6
    v_lshl_add_u32 v4, v5, 7, v4
    v_add_u32 v20, 57344, v4
    s_lshl_b32 s14, s9, 16
    s_add_u32 s14, s14, 262144
    s_lshr_b32 s15, s2, 3
    s_mul_i32 s15, s15, 0
    s_and_b32 s15, s15, 0xffff
    s_add_u32 s48, s14, s15
    s_add_u32 s15, s15, 4096
    s_and_b32 s15, s15, 0xffff
    s_add_u32 s49, s14, s15
    s_add_u32 s15, s15, 4096
    s_and_b32 s15, s15, 0xffff
    s_add_u32 s50, s14, s15
    s_add_u32 s15, s15, 4096
    s_and_b32 s15, s15, 0xffff
    s_add_u32 s51, s14, s15
    s_add_u32 s15, s15, 4096
    s_and_b32 s15, s15, 0xffff
    s_add_u32 s52, s14, s15
    s_add_u32 s15, s15, 4096
    s_and_b32 s15, s15, 0xffff
    s_add_u32 s53, s14, s15
    s_add_u32 s15, s15, 4096
    s_and_b32 s15, s15, 0xffff
    s_add_u32 s54, s14, s15
    s_add_u32 s15, s15, 4096
    s_and_b32 s15, s15, 0xffff
    s_add_u32 s55, s14, s15
    s_add_u32 s15, s15, 4096
    s_and_b32 s15, s15, 0xffff
    s_add_u32 s56, s14, s15
    s_add_u32 s15, s15, 4096
    s_and_b32 s15, s15, 0xffff
    s_add_u32 s57, s14, s15
    s_add_u32 s15, s15, 4096
    s_and_b32 s15, s15, 0xffff
    s_add_u32 s58, s14, s15
    s_add_u32 s15, s15, 4096
    s_and_b32 s15, s15, 0xffff
    s_add_u32 s59, s14, s15
    s_add_u32 s15, s15, 4096
    s_and_b32 s15, s15, 0xffff
    s_add_u32 s60, s14, s15
    s_add_u32 s15, s15, 4096
    s_and_b32 s15, s15, 0xffff
    s_add_u32 s61, s14, s15
    s_add_u32 s15, s15, 4096
    s_and_b32 s15, s15, 0xffff
    s_add_u32 s62, s14, s15
    s_add_u32 s15, s15, 4096
    s_and_b32 s15, s15, 0xffff
    s_add_u32 s63, s14, s15
    v_and_b32 v164, 31, v0
    v_lshlrev_b32 v164, 11, v164
    s_lshl_b32 s70, s4, 6
    s_add_u32 s70, s70, 163840
    v_add_u32 v164, s70, v164
    s_lshl_b32 s70, s8, 1
    s_add_u32 s71, s70, s10
    s_lshl_b32 s71, s71, 11
    s_add_u32 s71, s71, 115712
    v_add_u32 v155, s71, v1
    s_xor_b32 s71, s10, 1
    s_add_u32 s71, s71, s70
    s_lshl_b32 s71, s71, 11
    s_add_u32 s71, s71, 115712
    v_add_u32 v156, s71, v1
    s_lshl_b32 s70, s11, 8
    v_xor_b32 v157, s70, v1
    v_mul_u32_u24 v152, 12, v0
    s_cmp_eq_u32 s11, 0
    s_cselect_b64 s[96:97], -1, 0
    s_xor_b32 s70, s3, 4
    s_mul_i32 s70, s70, 3072
    s_add_u32 s70, s70, 115712
    v_add_u32 v160, s70, v1
    s_xor_b32 s70, s3, 2
    s_mul_i32 s70, s70, 3072
    s_add_u32 s70, s70, 116736
    v_add_u32 v161, s70, v1
    s_xor_b32 s70, s3, 6
    s_mul_i32 s70, s70, 3072
    s_add_u32 s70, s70, 117760
    v_add_u32 v6, s70, v1
    s_mul_i32 s70, s3, 3072
    s_add_u32 s70, s70, 115712
    v_add_u32 v7, s70, v1
    s_lshl_b32 s70, s8, 1
    s_add_u32 s70, s70, s10
    s_lshl_b32 s70, s70, 9
    s_add_u32 s70, s70, 141312
    v_and_b32 v8, 31, v0
    v_lshlrev_b32 v8, 4, v8
    v_add_u32 v8, s70, v8
    s_lshl_b32 s70, s9, 2
    v_add_u32 v9, s70, v8
    s_lshl_b32 s70, s8, 2
    v_add_u32 v162, s70, v21
    v_xor_b32 v10, 512, v9
    s_cmp_ge_u32 s3, 4
    s_cbranch_scc0 L_PA_1
    s_and_b32 s66, s9, 1
    v_bfe_u32 v11, v0, 4, 1
    v_lshlrev_b32 v11, 5, v11
    v_and_b32 v12, 3, v0
    v_lshl_add_u32 v11, v12, 3, v11
    s_lshl_b32 s70, s66, 6
    v_add_u32 v11, s70, v11
    v_bfe_u32 v12, v0, 3, 1
    v_lshlrev_b32 v12, 6, v12
    v_xor_b32 v11, v11, v12
    v_lshrrev_b32 v12, 5, v0
    v_lshlrev_b32 v12, 2, v12
    v_bfe_u32 v13, v0, 2, 2
    v_add_u32 v12, v12, v13
    v_lshl_add_u32 v11, v12, 7, v11
    s_mul_i32 s70, s66, 28672
    s_add_u32 s70, s70, 57344
    v_add_u32 v11, s70, v11
    s_and_b32 s67, s3, 3
    s_xor_b32 s70, s67, 2
    s_lshl_b32 s70, s70, 12
    s_add_u32 s70, s70, 115712
    v_add_u32 v13, s70, v1
    s_lshl_b32 s70, s67, 12
    s_add_u32 s70, s70, 115712
    v_add_u32 v14, s70, v1
    v_and_b32 v15, 15, v0
    v_mul_u32_u24 v15, 1792, v15
    v_lshrrev_b32 v43, 5, v0
    v_lshl_add_u32 v15, v43, 4, v15
    v_bfe_u32 v43, v0, 4, 1
    v_lshl_add_u32 v15, v43, 5, v15
    s_lshl_b32 s70, s4, 1
    s_add_u32 s70, s70, s8
    s_lshl_b32 s64, s70, 1
    s_add_u32 s64, s64, s66
    s_lshl_b32 s64, s64, 14
    s_add_u32 s64, s64, 1048576
    s_mul_i32 s70, s70, 57344
    s_cmp_gt_u32 s5, 1
    s_subb_u32 s71, s5, 0
    s_lshl_b32 s71, s71, 7
    s_add_u32 s70, s70, s71
    s_lshl_b32 s71, s66, 6
    s_add_u32 s70, s70, s71
    s_add_u32 s65, s70, 896
    s_add_u32 s70, s5, 0
    s_and_b32 s70, s70, 3
    s_lshl_b32 s71, s70, 12
    s_add_u32 s100, s71, s64
    s_mul_i32 s70, s70, 7168
    v_add_u32 v164, s70, v11
    s_add_u32 s70, s5, 1
    s_and_b32 s70, s70, 3
    s_lshl_b32 s71, s70, 12
    s_add_u32 s101, s71, s64
    s_mul_i32 s70, s70, 7168
    v_add_u32 v165, s70, v11
    s_add_u32 s70, s5, 2
    s_and_b32 s70, s70, 3
    s_lshl_b32 s71, s70, 12
    s_add_u32 s14, s71, s64
    s_mul_i32 s70, s70, 7168
    v_add_u32 v166, s70, v11
    s_add_u32 s70, s5, 3
    s_and_b32 s70, s70, 3
    s_lshl_b32 s71, s70, 12
    s_add_u32 s15, s71, s64
    s_mul_i32 s70, s70, 7168
    v_add_u32 v167, s70, v11
    s_lshl_b32 s70, s67, 2
    v_add_u32 v11, s70, v21
    v_xor_b32 v12, 8, v11
    s_branch L_PD_2
L_PA_1:
    s_lshl_b32 s14, s5, 6
    s_lshl_b32 s15, s3, 4
    s_add_u32 s14, s14, s15
    v_lshrrev_b32 v43, 3, v0
    v_and_b32 v44, 7, v0
    v_lshlrev_b32 v45, 13, v43
    v_lshl_add_u32 v12, v44, 4, v45
    v_lshlrev_b32 v13, 4, v44
    v_sub_u32 v13, v45, v13
    v_add_u32 v13, 112, v13
    v_lshlrev_b32 v14, 2, v43
    s_lshl_b32 s64, s14, 12
    s_lshl_b32 s70, s4, 7
    s_add_u32 s65, s64, s70
    s_add_u32 s65, s65, 5242880
    s_sub_u32 s64, s64, s70
    s_add_u32 s64, s64, 3149696
    s_lshl_b32 s66, s14, 1
    s_lshl_b32 s70, s3, 1
    v_lshrrev_b32 v11, 5, v0
    v_add_u32 v11, s70, v11
    v_xor_b32 v11, v11, v44
    v_lshlrev_b32 v11, 4, v11
    v_lshl_add_u32 v11, v44, 10, v11
    v_and_b32 v45, 3, v43
    v_lshl_add_u32 v11, v45, 2, v11
    v_add_u32 v11, 48640, v11
    v_mul_u32_u24 v15, 1792, v43
    v_xor_b32 v45, s70, v44
    v_lshl_add_u32 v15, v45, 4, v15
    s_mul_i32 s67, s4, 114688
    s_lshl_b32 s70, s5, 7
    s_add_u32 s67, s67, s70
    s_mul_i32 s70, s3, 28672
    s_add_u32 s67, s67, s70
L_PD_2:
    v_mov_b32 v56, 0
    v_mov_b32 v57, 0
    v_mov_b32 v58, 0
    v_mov_b32 v59, 0
    v_mov_b32 v60, 0
    v_mov_b32 v61, 0
    v_mov_b32 v62, 0
    v_mov_b32 v63, 0
    v_mov_b32 v64, 0
    v_mov_b32 v65, 0
    v_mov_b32 v66, 0
    v_mov_b32 v67, 0
    v_mov_b32 v68, 0
    v_mov_b32 v69, 0
    v_mov_b32 v70, 0
    v_mov_b32 v71, 0
    v_mov_b32 v72, 0
    v_mov_b32 v73, 0
    v_mov_b32 v74, 0
    v_mov_b32 v75, 0
    v_mov_b32 v76, 0
    v_mov_b32 v77, 0
    v_mov_b32 v78, 0
    v_mov_b32 v79, 0
    v_mov_b32 v80, 0
    v_mov_b32 v81, 0
    v_mov_b32 v82, 0
    v_mov_b32 v83, 0
    v_mov_b32 v84, 0
    v_mov_b32 v85, 0
    v_mov_b32 v86, 0
    v_mov_b32 v87, 0
    s_cmp_ge_u32 s3, 4
    s_cbranch_scc0 L_QW
    s_cmp_ge_u32 s3, 4
    s_cselect_b32 s70, 4, 0
    v_add_u32 v4, s70, v21
    s_waitcnt vmcnt(0)
    s_mov_b64 exec, 1
    ds_add_u32 v4, v3 offset:68
    s_mov_b64 exec, -1
    s_branch L_B3
L_QW:
    s_waitcnt vmcnt(0)
    s_mov_b64 exec, 1
    ds_add_u32 v21, v3 offset:68
    s_mov_b64 exec, -1
    s_mov_b32 s71, 960000
L_LW_3:
    ds_read_b32 v41, v21 offset:68
    s_waitcnt lgkmcnt(0)
    v_readfirstlane_b32 s70, v41
    s_sub_u32 s71, s71, 1
    s_cbranch_scc1 L_LK_4
    s_cmp_lt_u32 s70, 4
    s_cbranch_scc1 L_LW_3
L_LK_4:
    ds_read_b64_tr_b16 v[104:105], v20 offset:0
    ds_read_b64_tr_b16 v[106:107], v20 offset:512
    ds_read_b128 v[108:111], v16 offset:0
    ds_read_b64_tr_b16 v[112:113], v20 offset:2048
    ds_read_b64_tr_b16 v[114:115], v20 offset:2560
    ds_read_b128 v[116:119], v17 offset:0
    ds_read_b64_tr_b16 v[120:121], v20 offset:4096
    ds_read_b64_tr_b16 v[122:123], v20 offset:4608
    ds_read_b128 v[124:127], v18 offset:0
    ds_read_b64_tr_b16 v[128:129], v20 offset:6144
    ds_read_b64_tr_b16 v[130:131], v20 offset:6656
    ds_read_b128 v[132:135], v19 offset:0
    s_waitcnt lgkmcnt(9)
    v_mfma_f32_32x32x16_bf16 v[24:39], v[104:107], v[108:111], 0
    ds_read_b64_tr_b16 v[104:105], v20 offset:8192
    ds_read_b64_tr_b16 v[106:107], v20 offset:8704
    ds_read_b128 v[108:111], v16 offset:8192
    s_waitcnt lgkmcnt(9)
    v_mfma_f32_32x32x16_bf16 v[24:39], v[112:115], v[116:119], v[24:39]
    ds_read_b64_tr_b16 v[112:113], v20 offset:10240
    ds_read_b64_tr_b16 v[114:115], v20 offset:10752
    ds_read_b128 v[116:119], v17 offset:8192
    s_waitcnt lgkmcnt(9)
    v_mfma_f32_32x32x16_bf16 v[24:39], v[120:123], v[124:127], v[24:39]
    ds_read_b64_tr_b16 v[120:121], v20 offset:12288
    ds_read_b64_tr_b16 v[122:123], v20 offset:12800
    ds_read_b128 v[124:127], v18 offset:8192
    s_waitcnt lgkmcnt(9)
    v_mfma_f32_32x32x16_bf16 v[24:39], v[128:131], v[132:135], v[24:39]
    ds_read_b64_tr_b16 v[128:129], v20 offset:14336
    ds_read_b64_tr_b16 v[130:131], v20 offset:14848
    ds_read_b128 v[132:135], v19 offset:8192
    s_waitcnt lgkmcnt(9)
    v_mfma_f32_32x32x16_bf16 v[24:39], v[104:107], v[108:111], v[24:39]
    ds_read_b64_tr_b16 v[104:105], v20 offset:16384
    ds_read_b64_tr_b16 v[106:107], v20 offset:16896
    ds_read_b128 v[108:111], v16 offset:16384
    s_waitcnt lgkmcnt(9)
    v_mfma_f32_32x32x16_bf16 v[24:39], v[112:115], v[116:119], v[24:39]
    ds_read_b64_tr_b16 v[112:113], v20 offset:18432
    ds_read_b64_tr_b16 v[114:115], v20 offset:18944
    ds_read_b128 v[116:119], v17 offset:16384
    s_waitcnt lgkmcnt(9)
    v_mfma_f32_32x32x16_bf16 v[24:39], v[120:123], v[124:127], v[24:39]
    ds_read_b64_tr_b16 v[120:121], v20 offset:20480
    ds_read_b64_tr_b16 v[122:123], v20 offset:20992
    ds_read_b128 v[124:127], v18 offset:16384
    s_waitcnt lgkmcnt(9)
    v_mfma_f32_32x32x16_bf16 v[24:39], v[128:131], v[132:135], v[24:39]
    ds_read_b64_tr_b16 v[128:129], v20 offset:22528
    ds_read_b64_tr_b16 v[130:131], v20 offset:23040
    ds_read_b128 v[132:135], v19 offset:16384
    s_waitcnt lgkmcnt(9)
    v_mfma_f32_32x32x16_bf16 v[24:39], v[104:107], v[108:111], v[24:39]
    ds_read_b64_tr_b16 v[104:105], v20 offset:24576
    ds_read_b64_tr_b16 v[106:107], v20 offset:25088
    ds_read_b128 v[108:111], v16 offset:24576
    s_waitcnt lgkmcnt(9)
    v_mfma_f32_32x32x16_bf16 v[24:39], v[112:115], v[116:119], v[24:39]
    ds_read_b64_tr_b16 v[112:113], v20 offset:26624
    ds_read_b64_tr_b16 v[114:115], v20 offset:27136
    ds_read_b128 v[116:119], v17 offset:24576
    s_waitcnt lgkmcnt(9)
    v_mfma_f32_32x32x16_bf16 v[24:39], v[120:123], v[124:127], v[24:39]
    ds_read_b64_tr_b16 v[120:121], v20 offset:28672
    ds_read_b64_tr_b16 v[122:123], v20 offset:29184
    ds_read_b128 v[124:127], v18 offset:24576
    s_waitcnt lgkmcnt(9)
    v_mfma_f32_32x32x16_bf16 v[24:39], v[128:131], v[132:135], v[24:39]
    ds_read_b64_tr_b16 v[128:129], v20 offset:30720
    ds_read_b64_tr_b16 v[130:131], v20 offset:31232
    ds_read_b128 v[132:135], v19 offset:24576
    s_waitcnt lgkmcnt(9)
    v_mfma_f32_32x32x16_bf16 v[24:39], v[104:107], v[108:111], v[24:39]
    s_waitcnt lgkmcnt(6)
    v_mfma_f32_32x32x16_bf16 v[24:39], v[112:115], v[116:119], v[24:39]
    s_waitcnt lgkmcnt(3)
    v_mfma_f32_32x32x16_bf16 v[24:39], v[120:123], v[124:127], v[24:39]
    s_waitcnt lgkmcnt(0)
    v_mfma_f32_32x32x16_bf16 v[24:39], v[128:131], v[132:135], v[24:39]
    s_setprio 3
    s_mov_b32 s71, 960000
L_LW_5:
    ds_read_b32 v41, v21 offset:76
    s_waitcnt lgkmcnt(0)
    v_readfirstlane_b32 s70, v41
    s_sub_u32 s71, s71, 1
    s_cbranch_scc1 L_LK_6
    s_cmp_lt_u32 s70, 1
    s_cbranch_scc1 L_LW_5
L_LK_6:
    s_mov_b32 s71, 960000
L_LW_7:
    ds_read_b32 v41, v21 offset:72
    s_waitcnt lgkmcnt(0)
    v_readfirstlane_b32 s70, v41
    s_sub_u32 s71, s71, 1
    s_cbranch_scc1 L_LK_8
    s_cmp_lt_u32 s70, 3
    s_cbranch_scc1 L_LW_7
L_LK_8:
    ds_read_b64_tr_b16 v[104:105], v20 offset:32768
    ds_read_b64_tr_b16 v[106:107], v20 offset:33280
    ds_read_b128 v[108:111], v16 offset:32768
    ds_read_b64_tr_b16 v[112:113], v20 offset:34816
    ds_read_b64_tr_b16 v[114:115], v20 offset:35328
    ds_read_b128 v[116:119], v17 offset:32768
    ds_read_b64_tr_b16 v[120:121], v20 offset:36864
    ds_read_b64_tr_b16 v[122:123], v20 offset:37376
    ds_read_b128 v[124:127], v18 offset:32768
    ds_read_b64_tr_b16 v[128:129], v20 offset:38912
    ds_read_b64_tr_b16 v[130:131], v20 offset:39424
    ds_read_b128 v[132:135], v19 offset:32768
    s_waitcnt lgkmcnt(9)
    v_mfma_f32_32x32x16_bf16 v[24:39], v[104:107], v[108:111], v[24:39]
    ds_read_b64_tr_b16 v[104:105], v20 offset:40960
    ds_read_b64_tr_b16 v[106:107], v20 offset:41472
    ds_read_b128 v[108:111], v16 offset:40960
    s_waitcnt lgkmcnt(9)
    v_mfma_f32_32x32x16_bf16 v[24:39], v[112:115], v[116:119], v[24:39]
    ds_read_b64_tr_b16 v[112:113], v20 offset:43008
    ds_read_b64_tr_b16 v[114:115], v20 offset:43520
    ds_read_b128 v[116:119], v17 offset:40960
    s_waitcnt lgkmcnt(9)
    v_mfma_f32_32x32x16_bf16 v[24:39], v[120:123], v[124:127], v[24:39]
    ds_read_b64_tr_b16 v[120:121], v20 offset:45056
    ds_read_b64_tr_b16 v[122:123], v20 offset:45568
    ds_read_b128 v[124:127], v18 offset:40960
    s_waitcnt lgkmcnt(9)
    v_mfma_f32_32x32x16_bf16 v[24:39], v[128:131], v[132:135], v[24:39]
    ds_read_b64_tr_b16 v[128:129], v20 offset:47104
    ds_read_b64_tr_b16 v[130:131], v20 offset:47616
    ds_read_b128 v[132:135], v19 offset:40960
    s_waitcnt lgkmcnt(9)
    v_mfma_f32_32x32x16_bf16 v[24:39], v[104:107], v[108:111], v[24:39]
    ds_read_b64_tr_b16 v[104:105], v20 offset:49152
    ds_read_b64_tr_b16 v[106:107], v20 offset:49664
    ds_read_b128 v[108:111], v16 offset:49152
    s_waitcnt lgkmcnt(9)
    v_mfma_f32_32x32x16_bf16 v[24:39], v[112:115], v[116:119], v[24:39]
    ds_read_b64_tr_b16 v[112:113], v20 offset:51200
    ds_read_b64_tr_b16 v[114:115], v20 offset:51712
    ds_read_b128 v[116:119], v17 offset:49152
    s_waitcnt lgkmcnt(9)
    v_mfma_f32_32x32x16_bf16 v[24:39], v[120:123], v[124:127], v[24:39]
    ds_read_b64_tr_b16 v[120:121], v20 offset:53248
    ds_read_b64_tr_b16 v[122:123], v20 offset:53760
    ds_read_b128 v[124:127], v18 offset:49152
    s_waitcnt lgkmcnt(9)
    v_mfma_f32_32x32x16_bf16 v[24:39], v[128:131], v[132:135], v[24:39]
    ds_read_b64_tr_b16 v[128:129], v20 offset:55296
    ds_read_b64_tr_b16 v[130:131], v20 offset:55808
    ds_read_b128 v[132:135], v19 offset:49152
    s_waitcnt lgkmcnt(9)
    v_mfma_f32_32x32x16_bf16 v[24:39], v[104:107], v[108:111], v[24:39]
    s_waitcnt lgkmcnt(6)
    v_mfma_f32_32x32x16_bf16 v[24:39], v[112:115], v[116:119], v[24:39]
    s_waitcnt lgkmcnt(3)
    v_mfma_f32_32x32x16_bf16 v[24:39], v[120:123], v[124:127], v[24:39]
    s_waitcnt lgkmcnt(0)
    v_mfma_f32_32x32x16_bf16 v[24:39], v[128:131], v[132:135], v[24:39]
    s_mov_b32 s68, 0x3e8b97f6
    s_lshl_b32 s71, s3, 11
    s_add_u32 s71, s71, 115712
    v_add_u32 v4, s71, v1
    s_mov_b32 s69, s68
    s_nop 6
    v_pk_mul_f32 v[24:25], v[24:25], s[68:69]
    v_pk_mul_f32 v[26:27], v[26:27], s[68:69]
    v_pk_mul_f32 v[28:29], v[28:29], s[68:69]
    v_pk_mul_f32 v[30:31], v[30:31], s[68:69]
    v_pk_mul_f32 v[32:33], v[32:33], s[68:69]
    v_pk_mul_f32 v[34:35], v[34:35], s[68:69]
    v_pk_mul_f32 v[36:37], v[36:37], s[68:69]
    v_pk_mul_f32 v[38:39], v[38:39], s[68:69]
    v_cvt_pk_bf16_f32 v110, v36, v37
    v_cvt_pk_bf16_f32 v111, v38, v39
    v_cvt_pk_bf16_f32 v104, v24, v25
    v_cvt_pk_bf16_f32 v105, v26, v27
    v_cvt_pk_bf16_f32 v106, v28, v29
    v_cvt_pk_bf16_f32 v107, v30, v31
    v_cvt_pk_bf16_f32 v108, v32, v33
    v_cvt_pk_bf16_f32 v109, v34, v35
    v_permlane32_swap_b32 v110, v111
    v_mov_b32 v111, 0
    ds_write_b128 v4, v[104:107]
    ds_write_b128 v4, v[108:111] offset:1024
    s_mov_b64 exec, 1
    ds_add_u32 v21, v3 offset:80
    s_mov_b64 exec, -1
    s_branch L_B3
L_W7B:
    s_cmp_ge_u32 s3, 8
    s_cbranch_scc1 L_AUX
    s_setprio 3
    s_and_b32 s8, s3, 1
    s_lshr_b32 s9, s3, 1
    s_and_b32 s10, s9, 1
    s_lshr_b32 s11, s9, 1
    s_lshl_b32 s12, s4, 1
    s_add_u32 s12, s12, s8
    s_lshl_b32 s12, s12, 4
    s_lshl_b32 s13, s5, 1
    s_add_u32 s12, s12, s13
    s_add_u32 s12, s12, s10
    s_lshl_b32 s12, s12, 1
    s_add_u32 s12, s12, s11
    s_lshl_b32 s12, s12, 10
    s_add_u32 s12, s12, 1048576
    s_and_b32 s13, s5, 1
    s_lshr_b32 s15, s5, 1
    v_and_b32 v4, 31, v0
    v_lshrrev_b32 v5, 5, v0
    v_bfe_u32 v6, v0, 1, 3
    v_xor_b32 v5, v5, v6
    v_lshlrev_b32 v5, 4, v5
    v_lshl_add_u32 v5, v4, 7, v5
    s_lshl_b32 s70, s13, 12
    v_add_u32 v16, s70, v5
    v_xor_b32 v17, 32, v16
    v_xor_b32 v18, 64, v16
    v_xor_b32 v19, 96, v16
    v_lshrrev_b32 v4, 5, v0
    v_lshlrev_b32 v4, 3, v4
    v_bfe_u32 v5, v0, 2, 2
    v_add_u32 v4, v4, v5
    v_mul_u32_u24 v4, 56, v4
    v_bfe_u32 v5, v0, 4, 1
    v_lshl_add_u32 v4, v5, 5, v4
    v_and_b32 v5, 3, v0
    v_lshl_add_u32 v4, v5, 3, v4
    v_add_u32 v20, 115712, v4
    s_lshl_b32 s68, s4, 1
    s_add_u32 s68, s68, s13
    s_lshl_b32 s69, s68, 1
    s_add_u32 s69, s69, s15
    s_lshl_b32 s68, s69, 11
    s_add_u32 s68, s68, 262144
    s_mul_i32 s69, s69, 32
    s_add_u32 s69, s69, 7340032
    s_mov_b32 s13, s15
    s_mov_b32 s44, s42
    s_mov_b32 s45, s43
    s_mov_b32 s46, 16777216
    s_mov_b32 s47, 0x20000
    s_lshl_b32 s14, s9, 16
    s_add_u32 s14, s14, 262144
    s_lshr_b32 s15, s2, 3
    s_mul_i32 s15, s15, 0
    s_and_b32 s15, s15, 0xffff
    s_add_u32 s48, s14, s15
    s_add_u32 s15, s15, 4096
    s_and_b32 s15, s15, 0xffff
    s_add_u32 s49, s14, s15
    s_add_u32 s15, s15, 4096
    s_and_b32 s15, s15, 0xffff
    s_add_u32 s50, s14, s15
    s_add_u32 s15, s15, 4096
    s_and_b32 s15, s15, 0xffff
    s_add_u32 s51, s14, s15
    s_add_u32 s15, s15, 4096
    s_and_b32 s15, s15, 0xffff
    s_add_u32 s52, s14, s15
    s_add_u32 s15, s15, 4096
    s_and_b32 s15, s15, 0xffff
    s_add_u32 s53, s14, s15
    s_add_u32 s15, s15, 4096
    s_and_b32 s15, s15, 0xffff
    s_add_u32 s54, s14, s15
    s_add_u32 s15, s15, 4096
    s_and_b32 s15, s15, 0xffff
    s_add_u32 s55, s14, s15
    s_add_u32 s15, s15, 4096
    s_and_b32 s15, s15, 0xffff
    s_add_u32 s56, s14, s15
    s_add_u32 s15, s15, 4096
    s_and_b32 s15, s15, 0xffff
    s_add_u32 s57, s14, s15
    s_add_u32 s15, s15, 4096
    s_and_b32 s15, s15, 0xffff
    s_add_u32 s58, s14, s15
    s_add_u32 s15, s15, 4096
    s_and_b32 s15, s15, 0xffff
    s_add_u32 s59, s14, s15
    s_add_u32 s15, s15, 4096
    s_and_b32 s15, s15, 0xffff
    s_add_u32 s60, s14, s15
    s_add_u32 s15, s15, 4096
    s_and_b32 s15, s15, 0xffff
    s_add_u32 s61, s14, s15
    s_add_u32 s15, s15, 4096
    s_and_b32 s15, s15, 0xffff
    s_add_u32 s62, s14, s15
    s_add_u32 s15, s15, 4096
    s_and_b32 s15, s15, 0xffff
    s_add_u32 s63, s14, s15
    v_and_b32 v164, 31, v0
    v_lshlrev_b32 v164, 11, v164
    s_lshl_b32 s70, s4, 6
    s_add_u32 s70, s70, 163840
    v_add_u32 v164, s70, v164
    s_lshl_b32 s70, s8, 1
    s_add_u32 s71, s70, s10
    s_lshl_b32 s71, s71, 11
    s_add_u32 s71, s71, 115712
    v_add_u32 v155, s71, v1
    s_xor_b32 s71, s10, 1
    s_add_u32 s71, s71, s70
    s_lshl_b32 s71, s71, 11
    s_add_u32 s71, s71, 115712
    v_add_u32 v156, s71, v1
    s_lshl_b32 s70, s11, 8
    v_xor_b32 v157, s70, v1
    v_mul_u32_u24 v152, 12, v0
    s_cmp_eq_u32 s11, 0
    s_cselect_b64 s[96:97], -1, 0
    s_xor_b32 s70, s3, 4
    s_mul_i32 s70, s70, 3072
    s_add_u32 s70, s70, 115712
    v_add_u32 v160, s70, v1
    s_xor_b32 s70, s3, 2
    s_mul_i32 s70, s70, 3072
    s_add_u32 s70, s70, 116736
    v_add_u32 v161, s70, v1
    s_xor_b32 s70, s3, 6
    s_mul_i32 s70, s70, 3072
    s_add_u32 s70, s70, 117760
    v_add_u32 v6, s70, v1
    s_mul_i32 s70, s3, 3072
    s_add_u32 s70, s70, 115712
    v_add_u32 v7, s70, v1
    s_lshl_b32 s70, s8, 1
    s_add_u32 s70, s70, s10
    s_lshl_b32 s70, s70, 9
    s_add_u32 s70, s70, 141312
    v_and_b32 v8, 31, v0
    v_lshlrev_b32 v8, 4, v8
    v_add_u32 v8, s70, v8
    s_lshl_b32 s70, s9, 2
    v_add_u32 v9, s70, v8
    s_lshl_b32 s70, s8, 2
    v_add_u32 v162, s70, v21
    v_xor_b32 v10, 512, v9
    s_cmp_ge_u32 s3, 4
    s_cbranch_scc0 L_PA_9
    s_and_b32 s66, s9, 1
    v_bfe_u32 v11, v0, 4, 1
    v_lshlrev_b32 v11, 5, v11
    v_and_b32 v12, 3, v0
    v_lshl_add_u32 v11, v12, 3, v11
    s_lshl_b32 s70, s66, 6
    v_add_u32 v11, s70, v11
    v_bfe_u32 v12, v0, 3, 1
    v_lshlrev_b32 v12, 6, v12
    v_xor_b32 v11, v11, v12
    v_lshrrev_b32 v12, 5, v0
    v_lshlrev_b32 v12, 2, v12
    v_bfe_u32 v13, v0, 2, 2
    v_add_u32 v12, v12, v13
    v_lshl_add_u32 v11, v12, 7, v11
    s_mul_i32 s70, s66, 28672
    s_add_u32 s70, s70, 57344
    v_add_u32 v11, s70, v11
    s_and_b32 s67, s3, 3
    s_xor_b32 s70, s67, 2
    s_lshl_b32 s70, s70, 12
    s_add_u32 s70, s70, 115712
    v_add_u32 v13, s70, v1
    s_lshl_b32 s70, s67, 12
    s_add_u32 s70, s70, 115712
    v_add_u32 v14, s70, v1
    v_and_b32 v15, 15, v0
    v_mul_u32_u24 v15, 1792, v15
    v_lshrrev_b32 v43, 5, v0
    v_lshl_add_u32 v15, v43, 4, v15
    v_bfe_u32 v43, v0, 4, 1
    v_lshl_add_u32 v15, v43, 5, v15
    s_lshl_b32 s70, s4, 1
    s_add_u32 s70, s70, s8
    s_lshl_b32 s64, s70, 1
    s_add_u32 s64, s64, s66
    s_lshl_b32 s64, s64, 14
    s_add_u32 s64, s64, 1048576
    s_mul_i32 s70, s70, 57344
    s_cmp_gt_u32 s5, 1
    s_subb_u32 s71, s5, 0
    s_lshl_b32 s71, s71, 7
    s_add_u32 s70, s70, s71
    s_lshl_b32 s71, s66, 6
    s_add_u32 s70, s70, s71
    s_add_u32 s65, s70, 896
    s_add_u32 s70, s5, 0
    s_and_b32 s70, s70, 3
    s_lshl_b32 s71, s70, 12
    s_add_u32 s100, s71, s64
    s_mul_i32 s70, s70, 7168
    v_add_u32 v164, s70, v11
    s_add_u32 s70, s5, 1
    s_and_b32 s70, s70, 3
    s_lshl_b32 s71, s70, 12
    s_add_u32 s101, s71, s64
    s_mul_i32 s70, s70, 7168
    v_add_u32 v165, s70, v11
    s_add_u32 s70, s5, 2
    s_and_b32 s70, s70, 3
    s_lshl_b32 s71, s70, 12
    s_add_u32 s14, s71, s64
    s_mul_i32 s70, s70, 7168
    v_add_u32 v166, s70, v11
    s_add_u32 s70, s5, 3
    s_and_b32 s70, s70, 3
    s_lshl_b32 s71, s70, 12
    s_add_u32 s15, s71, s64
    s_mul_i32 s70, s70, 7168
    v_add_u32 v167, s70, v11
    s_lshl_b32 s70, s67, 2
    v_add_u32 v11, s70, v21
    v_xor_b32 v12, 8, v11
    s_branch L_PD_10
L_PA_9:
    s_lshl_b32 s14, s5, 6
    s_lshl_b32 s15, s3, 4
    s_add_u32 s14, s14, s15
    v_lshrrev_b32 v43, 3, v0
    v_and_b32 v44, 7, v0
    v_lshlrev_b32 v45, 13, v43
    v_lshl_add_u32 v12, v44, 4, v45
    v_lshlrev_b32 v13, 4, v44
    v_sub_u32 v13, v45, v13
    v_add_u32 v13, 112, v13
    v_lshlrev_b32 v14, 2, v43
    s_lshl_b32 s64, s14, 12
    s_lshl_b32 s70, s4, 7
    s_add_u32 s65, s64, s70
    s_add_u32 s65, s65, 5242880
    s_sub_u32 s64, s64, s70
    s_add_u32 s64, s64, 3149696
    s_lshl_b32 s66, s14, 1
    s_lshl_b32 s70, s3, 1
    v_lshrrev_b32 v11, 5, v0
    v_add_u32 v11, s70, v11
    v_xor_b32 v11, v11, v44
    v_lshlrev_b32 v11, 4, v11
    v_lshl_add_u32 v11, v44, 10, v11
    v_and_b32 v45, 3, v43
    v_lshl_add_u32 v11, v45, 2, v11
    v_add_u32 v11, 48640, v11
    v_mul_u32_u24 v15, 1792, v43
    v_xor_b32 v45, s70, v44
    v_lshl_add_u32 v15, v45, 4, v15
    s_mul_i32 s67, s4, 114688
    s_lshl_b32 s70, s5, 7
    s_add_u32 s67, s67, s70
    s_mul_i32 s70, s3, 28672
    s_add_u32 s67, s67, s70
L_PD_10:
    v_mov_b32 v56, 0
    v_mov_b32 v57, 0
    v_mov_b32 v58, 0
    v_mov_b32 v59, 0
    v_mov_b32 v60, 0
    v_mov_b32 v61, 0
    v_mov_b32 v62, 0
    v_mov_b32 v63, 0
    v_mov_b32 v64, 0
    v_mov_b32 v65, 0
    v_mov_b32 v66, 0
    v_mov_b32 v67, 0
    v_mov_b32 v68, 0
    v_mov_b32 v69, 0
    v_mov_b32 v70, 0
    v_mov_b32 v71, 0
    v_mov_b32 v72, 0
    v_mov_b32 v73, 0
    v_mov_b32 v74, 0
    v_mov_b32 v75, 0
    v_mov_b32 v76, 0
    v_mov_b32 v77, 0
    v_mov_b32 v78, 0
    v_mov_b32 v79, 0
    v_mov_b32 v80, 0
    v_mov_b32 v81, 0
    v_mov_b32 v82, 0
    v_mov_b32 v83, 0
    v_mov_b32 v84, 0
    v_mov_b32 v85, 0
    v_mov_b32 v86, 0
    v_mov_b32 v87, 0
    s_waitcnt lgkmcnt(0)
    s_mul_i32 s6, s6, 0x9E3779B1
    s_add_u32 s6, s6, 0x7F4A7C15
    s_mul_i32 s7, s7, 0x85EBCA6B
    s_add_u32 s7, s7, 0xC2B2AE35
    s_cmp_ge_u32 s5, 4
    s_cbranch_scc1 L_KV_SKIP
    v_and_b32 v4, 31, v0
    s_cmp_eq_u32 s13, 0
    s_cselect_b32 s70, 32, 28
    s_cselect_b32 s71, 63, 31
    v_and_b32 v5, s71, v0
    v_cmp_gt_u32 vcc, s70, v5
    v_cmp_eq_u32 s[74:75], 28, v4
    v_mov_b32 v23, 0x3f803f80
    v_mov_b32 v42, 0x00003f80
    s_cselect_b64 s[76:77], -1, 0
    v_cndmask_b32 v22, 0, -1, vcc
    s_or_b64 s[74:75], s[74:75], s[76:77]
    s_andn2_b64 s[74:75], s[74:75], vcc
    s_nop 0
    v_cndmask_b32 v23, 0, v23, s[74:75]
    v_cndmask_b32 v42, 0, v42, s[74:75]
    s_cmp_eq_u32 s13, 0
    s_cbranch_scc0 L_VPROJ
    s_mov_b32 s71, 960000
L_LW_11:
    ds_read_b32 v41, v21 offset:176
    s_waitcnt lgkmcnt(0)
    v_readfirstlane_b32 s70, v41
    s_sub_u32 s71, s71, 1
    s_cbranch_scc1 L_LK_12
    s_cmp_lt_u32 s70, 4
    s_cbranch_scc1 L_LW_11
L_LK_12:
    ds_read_b64_tr_b16 v[104:105], v20 offset:0
    ds_read_b64_tr_b16 v[106:107], v20 offset:224
    ds_read_b128 v[108:111], v16 offset:0
    ds_read_b64_tr_b16 v[112:113], v20 offset:896
    ds_read_b64_tr_b16 v[114:115], v20 offset:1120
    ds_read_b128 v[116:119], v17 offset:0
    ds_read_b64_tr_b16 v[120:121], v20 offset:1792
    ds_read_b64_tr_b16 v[122:123], v20 offset:2016
    ds_read_b128 v[124:127], v18 offset:0
    ds_read_b64_tr_b16 v[128:129], v20 offset:2688
    ds_read_b64_tr_b16 v[130:131], v20 offset:2912
    ds_read_b128 v[132:135], v19 offset:0
    s_waitcnt lgkmcnt(9)
    v_mfma_f32_32x32x16_bf16 v[24:39], v[104:107], v[108:111], 0
    ds_read_b64_tr_b16 v[104:105], v20 offset:3584
    ds_read_b64_tr_b16 v[106:107], v20 offset:3808
    ds_read_b128 v[108:111], v16 offset:8192
    s_waitcnt lgkmcnt(9)
    v_mfma_f32_32x32x16_bf16 v[24:39], v[112:115], v[116:119], v[24:39]
    ds_read_b64_tr_b16 v[112:113], v20 offset:4480
    ds_read_b64_tr_b16 v[114:115], v20 offset:4704
    ds_read_b128 v[116:119], v17 offset:8192
    s_waitcnt lgkmcnt(9)
    v_mfma_f32_32x32x16_bf16 v[24:39], v[120:123], v[124:127], v[24:39]
    ds_read_b64_tr_b16 v[120:121], v20 offset:5376
    ds_read_b64_tr_b16 v[122:123], v20 offset:5600
    ds_read_b128 v[124:127], v18 offset:8192
    s_waitcnt lgkmcnt(9)
    v_mfma_f32_32x32x16_bf16 v[24:39], v[128:131], v[132:135], v[24:39]
    ds_read_b64_tr_b16 v[128:129], v20 offset:6272
    ds_read_b64_tr_b16 v[130:131], v20 offset:6496
    ds_read_b128 v[132:135], v19 offset:8192
    s_waitcnt lgkmcnt(9)
    v_mfma_f32_32x32x16_bf16 v[24:39], v[104:107], v[108:111], v[24:39]
    ds_read_b64_tr_b16 v[104:105], v20 offset:7168
    ds_read_b64_tr_b16 v[106:107], v20 offset:7392
    ds_read_b128 v[108:111], v16 offset:16384
    s_waitcnt lgkmcnt(9)
    v_mfma_f32_32x32x16_bf16 v[24:39], v[112:115], v[116:119], v[24:39]
    ds_read_b64_tr_b16 v[112:113], v20 offset:8064
    ds_read_b64_tr_b16 v[114:115], v20 offset:8288
    ds_read_b128 v[116:119], v17 offset:16384
    s_waitcnt lgkmcnt(9)
    v_mfma_f32_32x32x16_bf16 v[24:39], v[120:123], v[124:127], v[24:39]
    ds_read_b64_tr_b16 v[120:121], v20 offset:8960
    ds_read_b64_tr_b16 v[122:123], v20 offset:9184
    ds_read_b128 v[124:127], v18 offset:16384
    s_waitcnt lgkmcnt(9)
    v_mfma_f32_32x32x16_bf16 v[24:39], v[128:131], v[132:135], v[24:39]
    ds_read_b64_tr_b16 v[128:129], v20 offset:9856
    ds_read_b64_tr_b16 v[130:131], v20 offset:10080
    ds_read_b128 v[132:135], v19 offset:16384
    s_waitcnt lgkmcnt(9)
    v_mfma_f32_32x32x16_bf16 v[24:39], v[104:107], v[108:111], v[24:39]
    ds_read_b64_tr_b16 v[104:105], v20 offset:10752
    ds_read_b64_tr_b16 v[106:107], v20 offset:10976
    ds_read_b128 v[108:111], v16 offset:24576
    s_waitcnt lgkmcnt(9)
    v_mfma_f32_32x32x16_bf16 v[24:39], v[112:115], v[116:119], v[24:39]
    ds_read_b64_tr_b16 v[112:113], v20 offset:11648
    ds_read_b64_tr_b16 v[114:115], v20 offset:11872
    ds_read_b128 v[116:119], v17 offset:24576
    s_waitcnt lgkmcnt(9)
    v_mfma_f32_32x32x16_bf16 v[24:39], v[120:123], v[124:127], v[24:39]
    ds_read_b64_tr_b16 v[120:121], v20 offset:12544
    ds_read_b64_tr_b16 v[122:123], v20 offset:12768
    ds_read_b128 v[124:127], v18 offset:24576
    s_waitcnt lgkmcnt(9)
    v_mfma_f32_32x32x16_bf16 v[24:39], v[128:131], v[132:135], v[24:39]
    ds_read_b64_tr_b16 v[128:129], v20 offset:13440
    ds_read_b64_tr_b16 v[130:131], v20 offset:13664
    ds_read_b128 v[132:135], v19 offset:24576
    s_waitcnt lgkmcnt(9)
    v_mfma_f32_32x32x16_bf16 v[24:39], v[104:107], v[108:111], v[24:39]
    s_waitcnt lgkmcnt(6)
    v_mfma_f32_32x32x16_bf16 v[24:39], v[112:115], v[116:119], v[24:39]
    s_waitcnt lgkmcnt(3)
    v_mfma_f32_32x32x16_bf16 v[24:39], v[120:123], v[124:127], v[24:39]
    s_waitcnt lgkmcnt(0)
    v_mfma_f32_32x32x16_bf16 v[24:39], v[128:131], v[132:135], v[24:39]
    s_mov_b32 s71, 960000
L_LW_13:
    ds_read_b32 v41, v21 offset:180
    s_waitcnt lgkmcnt(0)
    v_readfirstlane_b32 s70, v41
    s_sub_u32 s71, s71, 1
    s_cbranch_scc1 L_LK_14
    s_cmp_lt_u32 s70, 3
    s_cbranch_scc1 L_LW_13
L_LK_14:
    ds_read_b64_tr_b16 v[104:105], v20 offset:14336
    ds_read_b64_tr_b16 v[106:107], v20 offset:14560
    ds_read_b128 v[108:111], v16 offset:32768
    ds_read_b64_tr_b16 v[112:113], v20 offset:15232
    ds_read_b64_tr_b16 v[114:115], v20 offset:15456
    ds_read_b128 v[116:119], v17 offset:32768
    ds_read_b64_tr_b16 v[120:121], v20 offset:16128
    ds_read_b64_tr_b16 v[122:123], v20 offset:16352
    ds_read_b128 v[124:127], v18 offset:32768
    ds_read_b64_tr_b16 v[128:129], v20 offset:17024
    ds_read_b64_tr_b16 v[130:131], v20 offset:17248
    ds_read_b128 v[132:135], v19 offset:32768
    s_waitcnt lgkmcnt(9)
    v_mfma_f32_32x32x16_bf16 v[24:39], v[104:107], v[108:111], v[24:39]
    ds_read_b64_tr_b16 v[104:105], v20 offset:17920
    ds_read_b64_tr_b16 v[106:107], v20 offset:18144
    ds_read_b128 v[108:111], v16 offset:40960
    s_waitcnt lgkmcnt(9)
    v_mfma_f32_32x32x16_bf16 v[24:39], v[112:115], v[116:119], v[24:39]
    ds_read_b64_tr_b16 v[112:113], v20 offset:18816
    ds_read_b64_tr_b16 v[114:115], v20 offset:19040
    ds_read_b128 v[116:119], v17 offset:40960
    s_waitcnt lgkmcnt(9)
    v_mfma_f32_32x32x16_bf16 v[24:39], v[120:123], v[124:127], v[24:39]
    ds_read_b64_tr_b16 v[120:121], v20 offset:19712
    ds_read_b64_tr_b16 v[122:123], v20 offset:19936
    ds_read_b128 v[124:127], v18 offset:40960
    s_waitcnt lgkmcnt(9)
    v_mfma_f32_32x32x16_bf16 v[24:39], v[128:131], v[132:135], v[24:39]
    ds_read_b64_tr_b16 v[128:129], v20 offset:20608
    ds_read_b64_tr_b16 v[130:131], v20 offset:20832
    ds_read_b128 v[132:135], v19 offset:40960
    s_waitcnt lgkmcnt(9)
    v_mfma_f32_32x32x16_bf16 v[24:39], v[104:107], v[108:111], v[24:39]
    ds_read_b64_tr_b16 v[104:105], v20 offset:21504
    ds_read_b64_tr_b16 v[106:107], v20 offset:21728
    ds_read_b128 v[108:111], v16 offset:49152
    s_waitcnt lgkmcnt(9)
    v_mfma_f32_32x32x16_bf16 v[24:39], v[112:115], v[116:119], v[24:39]
    ds_read_b64_tr_b16 v[112:113], v20 offset:22400
    ds_read_b64_tr_b16 v[114:115], v20 offset:22624
    ds_read_b128 v[116:119], v17 offset:49152
    s_waitcnt lgkmcnt(9)
    v_mfma_f32_32x32x16_bf16 v[24:39], v[120:123], v[124:127], v[24:39]
    ds_read_b64_tr_b16 v[120:121], v20 offset:23296
    ds_read_b64_tr_b16 v[122:123], v20 offset:23520
    ds_read_b128 v[124:127], v18 offset:49152
    s_waitcnt lgkmcnt(9)
    v_mfma_f32_32x32x16_bf16 v[24:39], v[128:131], v[132:135], v[24:39]
    ds_read_b64_tr_b16 v[128:129], v20 offset:24192
    ds_read_b64_tr_b16 v[130:131], v20 offset:24416
    ds_read_b128 v[132:135], v19 offset:49152
    s_waitcnt lgkmcnt(9)
    v_mfma_f32_32x32x16_bf16 v[24:39], v[104:107], v[108:111], v[24:39]
    s_waitcnt lgkmcnt(6)
    v_mfma_f32_32x32x16_bf16 v[24:39], v[112:115], v[116:119], v[24:39]
    s_waitcnt lgkmcnt(3)
    v_mfma_f32_32x32x16_bf16 v[24:39], v[120:123], v[124:127], v[24:39]
    s_waitcnt lgkmcnt(0)
    v_mfma_f32_32x32x16_bf16 v[24:39], v[128:131], v[132:135], v[24:39]
    s_mov_b64 exec, 1
    ds_add_u32 v21, v3 offset:76
    s_mov_b64 exec, -1
    s_nop 7
    s_nop 0
    v_cvt_pk_bf16_f32 v110, v36, v37
    v_cvt_pk_bf16_f32 v111, v38, v39
    v_cvt_pk_bf16_f32 v104, v24, v25
    v_cvt_pk_bf16_f32 v105, v26, v27
    v_cvt_pk_bf16_f32 v106, v28, v29
    v_cvt_pk_bf16_f32 v107, v30, v31
    v_cvt_pk_bf16_f32 v108, v32, v33
    v_cvt_pk_bf16_f32 v109, v34, v35
    v_permlane32_swap_b32 v110, v111
    buffer_store_dwordx4 v[104:107], v1, s[44:47], s68 offen sc1
    buffer_store_dwordx3 v[108:110], v152, s[44:47], s68 offen offset:1024 sc1
    v_and_b32 v36, v22, v36
    v_and_b32 v37, v22, v37
    v_and_b32 v38, v22, v38
    v_and_b32 v39, v22, v39
    v_mul_f32 v41, v24, v24
    v_fmac_f32 v41, v25, v25
    v_fmac_f32 v41, v26, v26
    v_fmac_f32 v41, v27, v27
    v_fmac_f32 v41, v28, v28
    v_fmac_f32 v41, v29, v29
    v_fmac_f32 v41, v30, v30
    v_fmac_f32 v41, v31, v31
    v_fmac_f32 v41, v32, v32
    v_fmac_f32 v41, v33, v33
    v_fmac_f32 v41, v34, v34
    v_fmac_f32 v41, v35, v35
    v_fmac_f32 v41, v36, v36
    v_fmac_f32 v41, v37, v37
    v_fmac_f32 v41, v38, v38
    v_fmac_f32 v41, v39, v39
    v_mov_b32 v42, v41
    s_nop 1
    v_permlane32_swap_b32 v41, v42
    s_nop 1
    v_add_f32 v41, v41, v42
    s_nop 1
    v_max_f32_dpp v41, v41, v41 row_ror:8 row_mask:0xf bank_mask:0xf
    s_nop 1
    v_max_f32_dpp v41, v41, v41 row_ror:4 row_mask:0xf bank_mask:0xf
    s_nop 1
    v_max_f32_dpp v41, v41, v41 row_ror:2 row_mask:0xf bank_mask:0xf
    s_nop 1
    v_max_f32_dpp v41, v41, v41 row_ror:1 row_mask:0xf bank_mask:0xf
    v_mov_b32 v42, v41
    s_nop 1
    v_permlane16_swap_b32 v41, v42
    s_nop 1
    v_max_f32 v41, v41, v42
    v_mov_b32 v40, s6
    v_mul_u32_u24 v4, 4096, v0
    s_waitcnt vmcnt(0)
    s_mov_b64 exec, 255
    buffer_store_dwordx2 v[40:41], v4, s[44:47], s69 offen sc1
    s_mov_b64 exec, -1
    s_branch L_KVWAIT
L_VPROJ:
    s_mov_b32 s71, 960000
L_LW_15:
    ds_read_b32 v41, v21 offset:176
    s_waitcnt lgkmcnt(0)
    v_readfirstlane_b32 s70, v41
    s_sub_u32 s71, s71, 1
    s_cbranch_scc1 L_LK_16
    s_cmp_lt_u32 s70, 4
    s_cbranch_scc1 L_LW_15
L_LK_16:
    ds_read_b64_tr_b16 v[104:105], v20 offset:0
    ds_read_b64_tr_b16 v[106:107], v20 offset:224
    ds_read_b128 v[108:111], v16 offset:0
    ds_read_b64_tr_b16 v[112:113], v20 offset:896
    ds_read_b64_tr_b16 v[114:115], v20 offset:1120
    ds_read_b128 v[116:119], v17 offset:0
    ds_read_b64_tr_b16 v[120:121], v20 offset:1792
    ds_read_b64_tr_b16 v[122:123], v20 offset:2016
    ds_read_b128 v[124:127], v18 offset:0
    ds_read_b64_tr_b16 v[128:129], v20 offset:2688
    ds_read_b64_tr_b16 v[130:131], v20 offset:2912
    ds_read_b128 v[132:135], v19 offset:0
    s_waitcnt lgkmcnt(9)
    v_mfma_f32_32x32x16_bf16 v[24:39], v[108:111], v[104:107], 0
    ds_read_b64_tr_b16 v[104:105], v20 offset:3584
    ds_read_b64_tr_b16 v[106:107], v20 offset:3808
    ds_read_b128 v[108:111], v16 offset:8192
    s_waitcnt lgkmcnt(9)
    v_mfma_f32_32x32x16_bf16 v[24:39], v[116:119], v[112:115], v[24:39]
    ds_read_b64_tr_b16 v[112:113], v20 offset:4480
    ds_read_b64_tr_b16 v[114:115], v20 offset:4704
    ds_read_b128 v[116:119], v17 offset:8192
    s_waitcnt lgkmcnt(9)
    v_mfma_f32_32x32x16_bf16 v[24:39], v[124:127], v[120:123], v[24:39]
    ds_read_b64_tr_b16 v[120:121], v20 offset:5376
    ds_read_b64_tr_b16 v[122:123], v20 offset:5600
    ds_read_b128 v[124:127], v18 offset:8192
    s_waitcnt lgkmcnt(9)
    v_mfma_f32_32x32x16_bf16 v[24:39], v[132:135], v[128:131], v[24:39]
    ds_read_b64_tr_b16 v[128:129], v20 offset:6272
    ds_read_b64_tr_b16 v[130:131], v20 offset:6496
    ds_read_b128 v[132:135], v19 offset:8192
    s_waitcnt lgkmcnt(9)
    v_mfma_f32_32x32x16_bf16 v[24:39], v[108:111], v[104:107], v[24:39]
    ds_read_b64_tr_b16 v[104:105], v20 offset:7168
    ds_read_b64_tr_b16 v[106:107], v20 offset:7392
    ds_read_b128 v[108:111], v16 offset:16384
    s_waitcnt lgkmcnt(9)
    v_mfma_f32_32x32x16_bf16 v[24:39], v[116:119], v[112:115], v[24:39]
    ds_read_b64_tr_b16 v[112:113], v20 offset:8064
    ds_read_b64_tr_b16 v[114:115], v20 offset:8288
    ds_read_b128 v[116:119], v17 offset:16384
    s_waitcnt lgkmcnt(9)
    v_mfma_f32_32x32x16_bf16 v[24:39], v[124:127], v[120:123], v[24:39]
    ds_read_b64_tr_b16 v[120:121], v20 offset:8960
    ds_read_b64_tr_b16 v[122:123], v20 offset:9184
    ds_read_b128 v[124:127], v18 offset:16384
    s_waitcnt lgkmcnt(9)
    v_mfma_f32_32x32x16_bf16 v[24:39], v[132:135], v[128:131], v[24:39]
    ds_read_b64_tr_b16 v[128:129], v20 offset:9856
    ds_read_b64_tr_b16 v[130:131], v20 offset:10080
    ds_read_b128 v[132:135], v19 offset:16384
    s_waitcnt lgkmcnt(9)
    v_mfma_f32_32x32x16_bf16 v[24:39], v[108:111], v[104:107], v[24:39]
    ds_read_b64_tr_b16 v[104:105], v20 offset:10752
    ds_read_b64_tr_b16 v[106:107], v20 offset:10976
    ds_read_b128 v[108:111], v16 offset:24576
    s_waitcnt lgkmcnt(9)
    v_mfma_f32_32x32x16_bf16 v[24:39], v[116:119], v[112:115], v[24:39]
    ds_read_b64_tr_b16 v[112:113], v20 offset:11648
    ds_read_b64_tr_b16 v[114:115], v20 offset:11872
    ds_read_b128 v[116:119], v17 offset:24576
    s_waitcnt lgkmcnt(9)
    v_mfma_f32_32x32x16_bf16 v[24:39], v[124:127], v[120:123], v[24:39]
    ds_read_b64_tr_b16 v[120:121], v20 offset:12544
    ds_read_b64_tr_b16 v[122:123], v20 offset:12768
    ds_read_b128 v[124:127], v18 offset:24576
    s_waitcnt lgkmcnt(9)
    v_mfma_f32_32x32x16_bf16 v[24:39], v[132:135], v[128:131], v[24:39]
    ds_read_b64_tr_b16 v[128:129], v20 offset:13440
    ds_read_b64_tr_b16 v[130:131], v20 offset:13664
    ds_read_b128 v[132:135], v19 offset:24576
    s_waitcnt lgkmcnt(9)
    v_mfma_f32_32x32x16_bf16 v[24:39], v[108:111], v[104:107], v[24:39]
    s_waitcnt lgkmcnt(6)
    v_mfma_f32_32x32x16_bf16 v[24:39], v[116:119], v[112:115], v[24:39]
    s_waitcnt lgkmcnt(3)
    v_mfma_f32_32x32x16_bf16 v[24:39], v[124:127], v[120:123], v[24:39]
    s_waitcnt lgkmcnt(0)
    v_mfma_f32_32x32x16_bf16 v[24:39], v[132:135], v[128:131], v[24:39]
    s_mov_b32 s71, 960000
L_LW_17:
    ds_read_b32 v41, v21 offset:180
    s_waitcnt lgkmcnt(0)
    v_readfirstlane_b32 s70, v41
    s_sub_u32 s71, s71, 1
    s_cbranch_scc1 L_LK_18
    s_cmp_lt_u32 s70, 3
    s_cbranch_scc1 L_LW_17
L_LK_18:
    ds_read_b64_tr_b16 v[104:105], v20 offset:14336
    ds_read_b64_tr_b16 v[106:107], v20 offset:14560
    ds_read_b128 v[108:111], v16 offset:32768
    ds_read_b64_tr_b16 v[112:113], v20 offset:15232
    ds_read_b64_tr_b16 v[114:115], v20 offset:15456
    ds_read_b128 v[116:119], v17 offset:32768
    ds_read_b64_tr_b16 v[120:121], v20 offset:16128
    ds_read_b64_tr_b16 v[122:123], v20 offset:16352
    ds_read_b128 v[124:127], v18 offset:32768
    ds_read_b64_tr_b16 v[128:129], v20 offset:17024
    ds_read_b64_tr_b16 v[130:131], v20 offset:17248
    ds_read_b128 v[132:135], v19 offset:32768
    s_waitcnt lgkmcnt(9)
    v_mfma_f32_32x32x16_bf16 v[24:39], v[108:111], v[104:107], v[24:39]
    ds_read_b64_tr_b16 v[104:105], v20 offset:17920
    ds_read_b64_tr_b16 v[106:107], v20 offset:18144
    ds_read_b128 v[108:111], v16 offset:40960
    s_waitcnt lgkmcnt(9)
    v_mfma_f32_32x32x16_bf16 v[24:39], v[116:119], v[112:115], v[24:39]
    ds_read_b64_tr_b16 v[112:113], v20 offset:18816
    ds_read_b64_tr_b16 v[114:115], v20 offset:19040
    ds_read_b128 v[116:119], v17 offset:40960
    s_waitcnt lgkmcnt(9)
    v_mfma_f32_32x32x16_bf16 v[24:39], v[124:127], v[120:123], v[24:39]
    ds_read_b64_tr_b16 v[120:121], v20 offset:19712
    ds_read_b64_tr_b16 v[122:123], v20 offset:19936
    ds_read_b128 v[124:127], v18 offset:40960
    s_waitcnt lgkmcnt(9)
    v_mfma_f32_32x32x16_bf16 v[24:39], v[132:135], v[128:131], v[24:39]
    ds_read_b64_tr_b16 v[128:129], v20 offset:20608
    ds_read_b64_tr_b16 v[130:131], v20 offset:20832
    ds_read_b128 v[132:135], v19 offset:40960
    s_waitcnt lgkmcnt(9)
    v_mfma_f32_32x32x16_bf16 v[24:39], v[108:111], v[104:107], v[24:39]
    ds_read_b64_tr_b16 v[104:105], v20 offset:21504
    ds_read_b64_tr_b16 v[106:107], v20 offset:21728
    ds_read_b128 v[108:111], v16 offset:49152
    s_waitcnt lgkmcnt(9)
    v_mfma_f32_32x32x16_bf16 v[24:39], v[116:119], v[112:115], v[24:39]
    ds_read_b64_tr_b16 v[112:113], v20 offset:22400
    ds_read_b64_tr_b16 v[114:115], v20 offset:22624
    ds_read_b128 v[116:119], v17 offset:49152
    s_waitcnt lgkmcnt(9)
    v_mfma_f32_32x32x16_bf16 v[24:39], v[124:127], v[120:123], v[24:39]
    ds_read_b64_tr_b16 v[120:121], v20 offset:23296
    ds_read_b64_tr_b16 v[122:123], v20 offset:23520
    ds_read_b128 v[124:127], v18 offset:49152
    s_waitcnt lgkmcnt(9)
    v_mfma_f32_32x32x16_bf16 v[24:39], v[132:135], v[128:131], v[24:39]
    ds_read_b64_tr_b16 v[128:129], v20 offset:24192
    ds_read_b64_tr_b16 v[130:131], v20 offset:24416
    ds_read_b128 v[132:135], v19 offset:49152
    s_waitcnt lgkmcnt(9)
    v_mfma_f32_32x32x16_bf16 v[24:39], v[108:111], v[104:107], v[24:39]
    s_waitcnt lgkmcnt(6)
    v_mfma_f32_32x32x16_bf16 v[24:39], v[116:119], v[112:115], v[24:39]
    s_waitcnt lgkmcnt(3)
    v_mfma_f32_32x32x16_bf16 v[24:39], v[124:127], v[120:123], v[24:39]
    s_waitcnt lgkmcnt(0)
    v_mfma_f32_32x32x16_bf16 v[24:39], v[132:135], v[128:131], v[24:39]
    s_mov_b64 exec, 1
    ds_add_u32 v21, v3 offset:76
    s_mov_b64 exec, -1
    v_mov_b32 v41, 0
    s_nop 7
    v_cvt_pk_bf16_f32 v104, v24, v25
    v_cvt_pk_bf16_f32 v105, v26, v27
    v_cvt_pk_bf16_f32 v106, v28, v29
    v_cvt_pk_bf16_f32 v107, v30, v31
    v_cvt_pk_bf16_f32 v108, v32, v33
    v_cvt_pk_bf16_f32 v109, v34, v35
    v_cvt_pk_bf16_f32 v110, v36, v37
    v_cvt_pk_bf16_f32 v111, v38, v39
    v_and_or_b32 v104, v104, v22, v23
    v_and_or_b32 v105, v105, v22, v23
    v_and_or_b32 v106, v106, v22, v23
    v_and_or_b32 v107, v107, v22, v23
    v_and_or_b32 v108, v108, v22, v23
    v_and_or_b32 v109, v109, v22, v23
    v_and_or_b32 v110, v110, v22, v23
    v_and_or_b32 v111, v111, v22, v23
    buffer_store_dwordx4 v[104:107], v1, s[44:47], s68 offen sc1
    buffer_store_dwordx4 v[108:111], v1, s[44:47], s68 offen offset:1024 sc1
L_KV_PUB:
    v_mov_b32 v40, s6
    v_mul_u32_u24 v4, 4096, v0
    s_waitcnt vmcnt(0)
    s_mov_b64 exec, 255
    buffer_store_dwordx2 v[40:41], v4, s[44:47], s69 offen sc1
    s_mov_b64 exec, -1
    s_branch L_KVWAIT
L_KV_SKIP:
    s_mov_b64 exec, 1
    ds_add_u32 v21, v3 offset:76
    s_mov_b64 exec, -1
L_KVWAIT:
    s_mov_b32 s71, 960000
L_LW_19:
    ds_read_b32 v41, v21 offset:80
    s_waitcnt lgkmcnt(0)
    v_readfirstlane_b32 s70, v41
    s_sub_u32 s71, s71, 1
    s_cbranch_scc1 L_LK_20
    s_cmp_lt_u32 s70, 4
    s_cbranch_scc1 L_LW_19
L_LK_20:
    v_mul_u32_u24 v4, 32, v0
    v_add_u32 v5, 2048, v4
    s_and_b32 s98, s2, 7
    s_mul_i32 s98, s98, 4096
    s_add_u32 s98, s98, 7340032
    s_mov_b32 s99, 0
    s_mov_b32 s71, 60000
    s_mov_b64 s[72:73], -1
    s_mov_b64 s[74:75], -1
L_KVPOLL:
    s_mov_b64 exec, s[72:73]
    s_cbranch_execz L_KVP1
    buffer_load_dwordx2 v[24:25], v4, s[44:47], s98 offen sc1
L_KVP1:
    s_mov_b64 exec, s[74:75]
    s_cbranch_execz L_KVP2
    buffer_load_dwordx2 v[26:27], v5, s[44:47], s98 offen sc1
L_KVP2:
    s_mov_b64 exec, -1
    s_cmp_eq_u32 s99, 0
    s_cbranch_scc0 L_KVP3
    ds_read_b128 v[88:91], v155
    ds_read_b128 v[92:95], v155 offset:1024
    ds_read_b128 v[96:99], v156
    ds_read_b128 v[100:103], v156 offset:1024
    v_mov_b32 v2, v157
    v_mov_b32 v159, v21
    v_mov_b32 v163, 1
    v_mov_b32 v40, 0
    v_mov_b32 v43, 0
    v_lshl_add_u32 v42, v0, 2, v21
    v_mov_b32 v111, 0x3f803f80
    v_mov_b32 v127, 0x3f803f80
    v_mov_b32 v143, 0x3f803f80
    v_mov_b32 v153, -2
    s_cmp_eq_u32 s11, 0
    s_cselect_b32 exec_hi, 0, -1
    s_mov_b32 exec_lo, 0
    v_mov_b32 v153, 0
    s_mov_b64 exec, -1
    s_waitcnt lgkmcnt(0)
    v_dot2_f32_bf16 v40, v88, v88, v40
    v_dot2_f32_bf16 v43, v96, v96, v43
    v_dot2_f32_bf16 v40, v89, v89, v40
    v_dot2_f32_bf16 v43, v97, v97, v43
    v_dot2_f32_bf16 v40, v90, v90, v40
    v_dot2_f32_bf16 v43, v98, v98, v43
    v_dot2_f32_bf16 v40, v91, v91, v40
    v_dot2_f32_bf16 v43, v99, v99, v43
    v_dot2_f32_bf16 v40, v92, v92, v40
    v_dot2_f32_bf16 v43, v100, v100, v43
    v_dot2_f32_bf16 v40, v93, v93, v40
    v_dot2_f32_bf16 v43, v101, v101, v43
    v_dot2_f32_bf16 v40, v94, v94, v40
    v_dot2_f32_bf16 v43, v102, v102, v43
    v_dot2_f32_bf16 v40, v95, v95, v40
    v_dot2_f32_bf16 v43, v103, v103, v43
    v_xor_b32 v154, 64, v164
    v_xor_b32 v155, 64, v165
    v_xor_b32 v156, 64, v166
    v_xor_b32 v157, 64, v167
    v_mov_b32 v44, v40
    s_nop 1
    v_permlane32_swap_b32 v40, v44
    s_nop 1
    v_add_f32 v40, v40, v44
    v_mov_b32 v44, v43
    s_nop 1
    v_permlane32_swap_b32 v43, v44
    s_nop 1
    v_add_f32 v43, v43, v44
    v_max_f32 v40, v40, v43
    s_nop 1
    v_max_f32_dpp v40, v40, v40 row_ror:8 row_mask:0xf bank_mask:0xf
    s_nop 1
    v_max_f32_dpp v40, v40, v40 row_ror:4 row_mask:0xf bank_mask:0xf
    s_nop 1
    v_max_f32_dpp v40, v40, v40 row_ror:2 row_mask:0xf bank_mask:0xf
    s_nop 1
    v_max_f32_dpp v40, v40, v40 row_ror:1 row_mask:0xf bank_mask:0xf
    v_mov_b32 v44, v40
    s_nop 1
    v_permlane16_swap_b32 v40, v44
    s_nop 1
    v_max_f32 v40, v40, v44
    s_mov_b32 s71, 60000
    s_mov_b32 s99, 1
L_KVP3:
    s_waitcnt vmcnt(0)
    v_cmp_ne_u32 s[72:73], s6, v24
    v_cmp_ne_u32 s[74:75], s6, v26
    v_max_f32 v28, v25, v27
    s_nop 2
    s_or_b64 vcc, s[72:73], s[74:75]
    s_cbranch_scc0 L_KVOK
    s_sleep 1
    s_sub_u32 s71, s71, 1
    s_cbranch_scc0 L_KVPOLL
L_KVOK:
    ds_write_b32 v42, v28 offset:256
    s_mov_b64 exec, 1
    ds_add_u32 v21, v3 offset:140
    s_mov_b64 exec, -1
    s_setprio 0
    s_branch L_RDY
L_B3:
    s_setprio 3
    s_mov_b32 s71, 960000
L_LW_21:
    ds_read_b32 v41, v21 offset:80
    s_waitcnt lgkmcnt(0)
    v_readfirstlane_b32 s70, v41
    s_sub_u32 s71, s71, 1
    s_cbranch_scc1 L_LK_22
    s_cmp_lt_u32 s70, 4
    s_cbranch_scc1 L_LW_21
L_LK_22:
    ds_read_b128 v[88:91], v155
    ds_read_b128 v[92:95], v155 offset:1024
    ds_read_b128 v[96:99], v156
    ds_read_b128 v[100:103], v156 offset:1024
    v_mov_b32 v2, v157
    v_mov_b32 v159, v21
    v_mov_b32 v163, 1
    v_mov_b32 v40, 0
    v_mov_b32 v43, 0
    v_lshl_add_u32 v42, v0, 2, v21
    v_mov_b32 v111, 0x3f803f80
    v_mov_b32 v127, 0x3f803f80
    v_mov_b32 v143, 0x3f803f80
    v_mov_b32 v153, -2
    s_cmp_eq_u32 s11, 0
    s_cselect_b32 exec_hi, 0, -1
    s_mov_b32 exec_lo, 0
    v_mov_b32 v153, 0
    s_mov_b64 exec, -1
    s_waitcnt lgkmcnt(0)
    v_dot2_f32_bf16 v40, v88, v88, v40
    v_dot2_f32_bf16 v43, v96, v96, v43
    v_dot2_f32_bf16 v40, v89, v89, v40
    v_dot2_f32_bf16 v43, v97, v97, v43
    v_dot2_f32_bf16 v40, v90, v90, v40
    v_dot2_f32_bf16 v43, v98, v98, v43
    v_dot2_f32_bf16 v40, v91, v91, v40
    v_dot2_f32_bf16 v43, v99, v99, v43
    v_dot2_f32_bf16 v40, v92, v92, v40
    v_dot2_f32_bf16 v43, v100, v100, v43
    v_dot2_f32_bf16 v40, v93, v93, v40
    v_dot2_f32_bf16 v43, v101, v101, v43
    v_dot2_f32_bf16 v40, v94, v94, v40
    v_dot2_f32_bf16 v43, v102, v102, v43
    v_dot2_f32_bf16 v40, v95, v95, v40
    v_dot2_f32_bf16 v43, v103, v103, v43
    v_xor_b32 v154, 64, v164
    v_xor_b32 v155, 64, v165
    v_xor_b32 v156, 64, v166
    v_xor_b32 v157, 64, v167
    v_mov_b32 v44, v40
    s_nop 1
    v_permlane32_swap_b32 v40, v44
    s_nop 1
    v_add_f32 v40, v40, v44
    v_mov_b32 v44, v43
    s_nop 1
    v_permlane32_swap_b32 v43, v44
    s_nop 1
    v_add_f32 v43, v43, v44
    v_max_f32 v40, v40, v43
    s_nop 1
    v_max_f32_dpp v40, v40, v40 row_ror:8 row_mask:0xf bank_mask:0xf
    s_nop 1
    v_max_f32_dpp v40, v40, v40 row_ror:4 row_mask:0xf bank_mask:0xf
    s_nop 1
    v_max_f32_dpp v40, v40, v40 row_ror:2 row_mask:0xf bank_mask:0xf
    s_nop 1
    v_max_f32_dpp v40, v40, v40 row_ror:1 row_mask:0xf bank_mask:0xf
    v_mov_b32 v44, v40
    s_nop 1
    v_permlane16_swap_b32 v40, v44
    s_nop 1
    v_max_f32 v40, v40, v44
    s_mov_b32 s71, 960000
L_LW_23:
    ds_read_b32 v41, v21 offset:140
    s_waitcnt lgkmcnt(0)
    v_readfirstlane_b32 s70, v41
    s_sub_u32 s71, s71, 1
    s_cbranch_scc1 L_LK_24
    s_cmp_lt_u32 s70, 1
    s_cbranch_scc1 L_LW_23
L_LK_24:
L_RDY:
    s_setprio 3
    buffer_load_dwordx4 v[104:107], v1, s[44:47], s48 offen
    buffer_load_dwordx3 v[108:110], v152, s[44:47], s48 offen offset:1024
    ds_read_b32 v41, v42 offset:256
    s_setprio 2
    buffer_load_dwordx4 v[112:115], v2, s[44:47], s48 offen offset:2048
    buffer_load_dwordx4 v[116:119], v2, s[44:47], s48 offen offset:3072
    buffer_load_dwordx4 v[120:123], v1, s[44:47], s49 offen
    buffer_load_dwordx3 v[124:126], v152, s[44:47], s49 offen offset:1024
    s_setprio 0
    buffer_load_dwordx4 v[128:131], v2, s[44:47], s49 offen offset:2048
    buffer_load_dwordx4 v[132:135], v2, s[44:47], s49 offen offset:3072
    buffer_load_dwordx4 v[136:139], v1, s[44:47], s50 offen
    buffer_load_dwordx3 v[140:142], v152, s[44:47], s50 offen offset:1024
    s_mov_b64 exec, 1
    ds_add_u32 v21, v3 offset:136
    s_mov_b64 exec, -1
    v_mov_b32 v25, 0x447a0000
    s_waitcnt lgkmcnt(0)
    v_mul_f32 v41, v41, v40
    v_cmp_nle_f32 vcc, v41, v25
    s_nop 3
    s_cbranch_vccnz L_SLOW
L_ATT:
    s_waitcnt vmcnt(8)
    v_mfma_f32_32x32x16_bf16 v[24:39], v[104:107], v[88:91], 0
    v_mfma_f32_32x32x16_bf16 v[24:39], v[108:111], v[92:95], v[24:39]
    s_nop 7
    s_nop 3
.p2align 3
    s_setprio 2
    v_exp_f32_e64 v24, v24
    v_exp_f32 v25, v25
    v_exp_f32 v26, v26
    v_exp_f32 v27, v27
    v_cvt_pk_bf16_f32 v16, v24, v25
    v_exp_f32 v28, v28
    v_exp_f32 v29, v29
    v_mfma_f32_32x32x16_bf16 v[40:55], v[104:107], v[96:99], 0
    v_cvt_pk_bf16_f32 v17, v26, v27
    v_exp_f32 v30, v30
    v_exp_f32 v31, v31
    v_cvt_pk_bf16_f32 v18, v28, v29
    v_exp_f32 v32, v32
    v_exp_f32 v33, v33
    v_mfma_f32_32x32x16_bf16 v[40:55], v[108:111], v[100:103], v[40:55]
    buffer_load_dwordx4 v[144:147], v2, s[44:47], s50 offen offset:2048
    buffer_load_dwordx4 v[148:151], v2, s[44:47], s50 offen offset:3072
    buffer_load_dwordx4 v[104:107], v1, s[44:47], s51 offen
    buffer_load_dwordx3 v[108:110], v152, s[44:47], s51 offen offset:1024
    s_waitcnt vmcnt(8)
    v_cvt_pk_bf16_f32 v19, v30, v31
    v_exp_f32_e64 v34, v34
    v_exp_f32 v35, v35
    v_mfma_f32_32x32x16_bf16 v[56:71], v[112:115], v[16:19], v[56:71]
    v_cvt_pk_bf16_f32 v20, v32, v33
    v_exp_f32 v36, v36
    v_exp_f32 v37, v37
    v_cvt_pk_bf16_f32 v21, v34, v35
    v_exp_f32 v38, v38
    v_exp_f32 v39, v39
    v_cvt_pk_bf16_f32 v22, v36, v37
    v_cvt_pk_bf16_f32 v23, v38, v39
    s_setprio 1
    v_exp_f32_e64 v40, v40
    v_exp_f32 v41, v41
    v_mfma_f32_32x32x16_bf16 v[56:71], v[116:119], v[20:23], v[56:71]
    v_exp_f32 v42, v42
    v_exp_f32 v43, v43
    v_cvt_pk_bf16_f32 v16, v40, v41
    v_exp_f32 v44, v44
    v_exp_f32 v45, v45
    v_mfma_f32_32x32x16_bf16 v[24:39], v[120:123], v[88:91], 0
    v_cvt_pk_bf16_f32 v17, v42, v43
    v_exp_f32 v46, v46
    v_exp_f32 v47, v47
    v_cvt_pk_bf16_f32 v18, v44, v45
    v_exp_f32 v48, v48
    v_exp_f32 v49, v49
    v_mfma_f32_32x32x16_bf16 v[24:39], v[124:127], v[92:95], v[24:39]
    v_cvt_pk_bf16_f32 v19, v46, v47
    v_exp_f32 v50, v50
    v_exp_f32 v51, v51
    v_mfma_f32_32x32x16_bf16 v[72:87], v[112:115], v[16:19], v[72:87]
    v_cvt_pk_bf16_f32 v20, v48, v49
    v_exp_f32 v52, v52
    v_exp_f32 v53, v53
    v_cvt_pk_bf16_f32 v21, v50, v51
    v_exp_f32 v54, v54
    v_exp_f32 v55, v55
    v_cvt_pk_bf16_f32 v22, v52, v53
    v_cvt_pk_bf16_f32 v23, v54, v55
    s_setprio 2
    v_exp_f32_e64 v24, v24
    v_exp_f32 v25, v25
    v_mfma_f32_32x32x16_bf16 v[72:87], v[116:119], v[20:23], v[72:87]
    v_exp_f32 v26, v26
    v_exp_f32 v27, v27
    v_cvt_pk_bf16_f32 v16, v24, v25
    v_exp_f32 v28, v28
    v_exp_f32 v29, v29
    v_mfma_f32_32x32x16_bf16 v[40:55], v[120:123], v[96:99], 0
    v_cvt_pk_bf16_f32 v17, v26, v27
    v_exp_f32 v30, v30
    v_exp_f32 v31, v31
    v_cvt_pk_bf16_f32 v18, v28, v29
    v_exp_f32 v32, v32
    v_exp_f32 v33, v33
    v_mfma_f32_32x32x16_bf16 v[40:55], v[124:127], v[100:103], v[40:55]
    buffer_load_dwordx4 v[112:115], v2, s[44:47], s51 offen offset:2048
    buffer_load_dwordx4 v[116:119], v2, s[44:47], s51 offen offset:3072
    buffer_load_dwordx4 v[120:123], v1, s[44:47], s52 offen
    buffer_load_dwordx3 v[124:126], v152, s[44:47], s52 offen offset:1024
    s_waitcnt vmcnt(8)
    v_cvt_pk_bf16_f32 v19, v30, v31
    v_exp_f32_e64 v34, v34
    v_exp_f32 v35, v35
    v_mfma_f32_32x32x16_bf16 v[56:71], v[128:131], v[16:19], v[56:71]
    v_cvt_pk_bf16_f32 v20, v32, v33
    v_exp_f32 v36, v36
    v_exp_f32 v37, v37
    v_cvt_pk_bf16_f32 v21, v34, v35
    v_exp_f32 v38, v38
    v_exp_f32 v39, v39
    v_cvt_pk_bf16_f32 v22, v36, v37
    v_cvt_pk_bf16_f32 v23, v38, v39
    s_setprio 1
    v_exp_f32_e64 v40, v40
    v_exp_f32 v41, v41
    v_mfma_f32_32x32x16_bf16 v[56:71], v[132:135], v[20:23], v[56:71]
    v_exp_f32 v42, v42
    v_exp_f32 v43, v43
    v_cvt_pk_bf16_f32 v16, v40, v41
    v_exp_f32 v44, v44
    v_exp_f32 v45, v45
    v_mfma_f32_32x32x16_bf16 v[24:39], v[136:139], v[88:91], 0
    v_cvt_pk_bf16_f32 v17, v42, v43
    v_exp_f32 v46, v46
    v_exp_f32 v47, v47
    v_cvt_pk_bf16_f32 v18, v44, v45
    v_exp_f32 v48, v48
    v_exp_f32 v49, v49
    v_mfma_f32_32x32x16_bf16 v[24:39], v[140:143], v[92:95], v[24:39]
    v_cvt_pk_bf16_f32 v19, v46, v47
    v_exp_f32 v50, v50
    v_exp_f32 v51, v51
    v_mfma_f32_32x32x16_bf16 v[72:87], v[128:131], v[16:19], v[72:87]
    v_cvt_pk_bf16_f32 v20, v48, v49
    v_exp_f32 v52, v52
    v_exp_f32 v53, v53
    v_cvt_pk_bf16_f32 v21, v50, v51
    v_exp_f32 v54, v54
    v_exp_f32 v55, v55
    v_cvt_pk_bf16_f32 v22, v52, v53
    v_cvt_pk_bf16_f32 v23, v54, v55
    s_setprio 2
    v_exp_f32_e64 v24, v24
    v_exp_f32 v25, v25
    v_mfma_f32_32x32x16_bf16 v[72:87], v[132:135], v[20:23], v[72:87]
    v_exp_f32 v26, v26
    v_exp_f32 v27, v27
    v_cvt_pk_bf16_f32 v16, v24, v25
    v_exp_f32 v28, v28
    v_exp_f32 v29, v29
    v_mfma_f32_32x32x16_bf16 v[40:55], v[136:139], v[96:99], 0
    v_cvt_pk_bf16_f32 v17, v26, v27
    v_exp_f32 v30, v30
    v_exp_f32 v31, v31
    v_cvt_pk_bf16_f32 v18, v28, v29
    v_exp_f32 v32, v32
    v_exp_f32 v33, v33
    v_mfma_f32_32x32x16_bf16 v[40:55], v[140:143], v[100:103], v[40:55]
    buffer_load_dwordx4 v[128:131], v2, s[44:47], s52 offen offset:2048
    buffer_load_dwordx4 v[132:135], v2, s[44:47], s52 offen offset:3072
    buffer_load_dwordx4 v[136:139], v1, s[44:47], s53 offen
    buffer_load_dwordx3 v[140:142], v152, s[44:47], s53 offen offset:1024
    s_waitcnt vmcnt(8)
    v_cvt_pk_bf16_f32 v19, v30, v31
    v_exp_f32_e64 v34, v34
    v_exp_f32 v35, v35
    v_mfma_f32_32x32x16_bf16 v[56:71], v[144:147], v[16:19], v[56:71]
    v_cvt_pk_bf16_f32 v20, v32, v33
    v_exp_f32 v36, v36
    v_exp_f32 v37, v37
    v_cvt_pk_bf16_f32 v21, v34, v35
    v_exp_f32 v38, v38
    v_exp_f32 v39, v39
    v_cvt_pk_bf16_f32 v22, v36, v37
    v_cvt_pk_bf16_f32 v23, v38, v39
    s_setprio 1
    v_exp_f32_e64 v40, v40
    v_exp_f32 v41, v41
    v_mfma_f32_32x32x16_bf16 v[56:71], v[148:151], v[20:23], v[56:71]
    v_exp_f32 v42, v42
    v_exp_f32 v43, v43
    v_cvt_pk_bf16_f32 v16, v40, v41
    v_exp_f32 v44, v44
    v_exp_f32 v45, v45
    v_mfma_f32_32x32x16_bf16 v[24:39], v[104:107], v[88:91], 0
    v_cvt_pk_bf16_f32 v17, v42, v43
    v_exp_f32 v46, v46
    v_exp_f32 v47, v47
    v_cvt_pk_bf16_f32 v18, v44, v45
    v_exp_f32 v48, v48
    v_exp_f32 v49, v49
    v_mfma_f32_32x32x16_bf16 v[24:39], v[108:111], v[92:95], v[24:39]
    v_cvt_pk_bf16_f32 v19, v46, v47
    v_exp_f32 v50, v50
    v_exp_f32 v51, v51
    v_mfma_f32_32x32x16_bf16 v[72:87], v[144:147], v[16:19], v[72:87]
    v_cvt_pk_bf16_f32 v20, v48, v49
    v_exp_f32 v52, v52
    v_exp_f32 v53, v53
    v_cvt_pk_bf16_f32 v21, v50, v51
    v_exp_f32 v54, v54
    v_exp_f32 v55, v55
    v_cvt_pk_bf16_f32 v22, v52, v53
    v_cvt_pk_bf16_f32 v23, v54, v55
    s_setprio 2
    v_exp_f32_e64 v24, v24
    v_exp_f32 v25, v25
    v_mfma_f32_32x32x16_bf16 v[72:87], v[148:151], v[20:23], v[72:87]
    v_exp_f32 v26, v26
    v_exp_f32 v27, v27
    v_cvt_pk_bf16_f32 v16, v24, v25
    v_exp_f32 v28, v28
    v_exp_f32 v29, v29
    v_mfma_f32_32x32x16_bf16 v[40:55], v[104:107], v[96:99], 0
    v_cvt_pk_bf16_f32 v17, v26, v27
    v_exp_f32 v30, v30
    v_exp_f32 v31, v31
    v_cvt_pk_bf16_f32 v18, v28, v29
    v_exp_f32 v32, v32
    v_exp_f32 v33, v33
    v_mfma_f32_32x32x16_bf16 v[40:55], v[108:111], v[100:103], v[40:55]
    buffer_load_dwordx4 v[144:147], v2, s[44:47], s53 offen offset:2048
    buffer_load_dwordx4 v[148:151], v2, s[44:47], s53 offen offset:3072
    buffer_load_dwordx4 v[104:107], v1, s[44:47], s54 offen
    buffer_load_dwordx3 v[108:110], v152, s[44:47], s54 offen offset:1024
    s_waitcnt vmcnt(8)
    v_cvt_pk_bf16_f32 v19, v30, v31
    v_exp_f32_e64 v34, v34
    v_exp_f32 v35, v35
    v_mfma_f32_32x32x16_bf16 v[56:71], v[112:115], v[16:19], v[56:71]
    v_cvt_pk_bf16_f32 v20, v32, v33
    v_exp_f32 v36, v36
    v_exp_f32 v37, v37
    v_cvt_pk_bf16_f32 v21, v34, v35
    v_exp_f32 v38, v38
    v_exp_f32 v39, v39
    v_cvt_pk_bf16_f32 v22, v36, v37
    v_cvt_pk_bf16_f32 v23, v38, v39
    s_setprio 1
    v_exp_f32_e64 v40, v40
    v_exp_f32 v41, v41
    v_mfma_f32_32x32x16_bf16 v[56:71], v[116:119], v[20:23], v[56:71]
    v_exp_f32 v42, v42
    v_exp_f32 v43, v43
    v_cvt_pk_bf16_f32 v16, v40, v41
    v_exp_f32 v44, v44
    v_exp_f32 v45, v45
    v_mfma_f32_32x32x16_bf16 v[24:39], v[120:123], v[88:91], 0
    v_cvt_pk_bf16_f32 v17, v42, v43
    v_exp_f32 v46, v46
    v_exp_f32 v47, v47
    v_cvt_pk_bf16_f32 v18, v44, v45
    v_exp_f32 v48, v48
    v_exp_f32 v49, v49
    v_mfma_f32_32x32x16_bf16 v[24:39], v[124:127], v[92:95], v[24:39]
    v_cvt_pk_bf16_f32 v19, v46, v47
    v_exp_f32 v50, v50
    v_exp_f32 v51, v51
    v_mfma_f32_32x32x16_bf16 v[72:87], v[112:115], v[16:19], v[72:87]
    v_cvt_pk_bf16_f32 v20, v48, v49
    v_exp_f32 v52, v52
    v_exp_f32 v53, v53
    v_cvt_pk_bf16_f32 v21, v50, v51
    v_exp_f32 v54, v54
    v_exp_f32 v55, v55
    v_cvt_pk_bf16_f32 v22, v52, v53
    v_cvt_pk_bf16_f32 v23, v54, v55
    s_setprio 2
    v_exp_f32_e64 v24, v24
    v_exp_f32 v25, v25
    v_mfma_f32_32x32x16_bf16 v[72:87], v[116:119], v[20:23], v[72:87]
    v_exp_f32 v26, v26
    v_exp_f32 v27, v27
    v_cvt_pk_bf16_f32 v16, v24, v25
    v_exp_f32 v28, v28
    v_exp_f32 v29, v29
    v_mfma_f32_32x32x16_bf16 v[40:55], v[120:123], v[96:99], 0
    v_cvt_pk_bf16_f32 v17, v26, v27
    v_exp_f32 v30, v30
    v_exp_f32 v31, v31
    v_cvt_pk_bf16_f32 v18, v28, v29
    v_exp_f32 v32, v32
    v_exp_f32 v33, v33
    v_mfma_f32_32x32x16_bf16 v[40:55], v[124:127], v[100:103], v[40:55]
    buffer_load_dwordx4 v[112:115], v2, s[44:47], s54 offen offset:2048
    buffer_load_dwordx4 v[116:119], v2, s[44:47], s54 offen offset:3072
    buffer_load_dwordx4 v[120:123], v1, s[44:47], s55 offen
    buffer_load_dwordx3 v[124:126], v152, s[44:47], s55 offen offset:1024
    s_waitcnt vmcnt(8)
    v_cvt_pk_bf16_f32 v19, v30, v31
    v_exp_f32_e64 v34, v34
    v_exp_f32 v35, v35
    v_mfma_f32_32x32x16_bf16 v[56:71], v[128:131], v[16:19], v[56:71]
    v_cvt_pk_bf16_f32 v20, v32, v33
    v_exp_f32 v36, v36
    v_exp_f32 v37, v37
    v_cvt_pk_bf16_f32 v21, v34, v35
    v_exp_f32 v38, v38
    v_exp_f32 v39, v39
    v_cvt_pk_bf16_f32 v22, v36, v37
    v_cvt_pk_bf16_f32 v23, v38, v39
    s_setprio 1
    v_exp_f32_e64 v40, v40
    v_exp_f32 v41, v41
    v_mfma_f32_32x32x16_bf16 v[56:71], v[132:135], v[20:23], v[56:71]
    v_exp_f32 v42, v42
    v_exp_f32 v43, v43
    v_cvt_pk_bf16_f32 v16, v40, v41
    v_exp_f32 v44, v44
    v_exp_f32 v45, v45
    v_mfma_f32_32x32x16_bf16 v[24:39], v[136:139], v[88:91], 0
    v_cvt_pk_bf16_f32 v17, v42, v43
    v_exp_f32 v46, v46
    v_exp_f32 v47, v47
    v_cvt_pk_bf16_f32 v18, v44, v45
    v_exp_f32 v48, v48
    v_exp_f32 v49, v49
    v_mfma_f32_32x32x16_bf16 v[24:39], v[140:143], v[92:95], v[24:39]
    v_cvt_pk_bf16_f32 v19, v46, v47
    v_exp_f32 v50, v50
    v_exp_f32 v51, v51
    v_mfma_f32_32x32x16_bf16 v[72:87], v[128:131], v[16:19], v[72:87]
    v_cvt_pk_bf16_f32 v20, v48, v49
    v_exp_f32 v52, v52
    v_exp_f32 v53, v53
    v_cvt_pk_bf16_f32 v21, v50, v51
    v_exp_f32 v54, v54
    v_exp_f32 v55, v55
    v_cvt_pk_bf16_f32 v22, v52, v53
    v_cvt_pk_bf16_f32 v23, v54, v55
    s_setprio 2
    v_exp_f32_e64 v24, v24
    v_exp_f32 v25, v25
    v_mfma_f32_32x32x16_bf16 v[72:87], v[132:135], v[20:23], v[72:87]
    v_exp_f32 v26, v26
    v_exp_f32 v27, v27
    v_cvt_pk_bf16_f32 v16, v24, v25
    v_exp_f32 v28, v28
    v_exp_f32 v29, v29
    v_mfma_f32_32x32x16_bf16 v[40:55], v[136:139], v[96:99], 0
    v_cvt_pk_bf16_f32 v17, v26, v27
    v_exp_f32 v30, v30
    v_exp_f32 v31, v31
    v_cvt_pk_bf16_f32 v18, v28, v29
    v_exp_f32 v32, v32
    v_exp_f32 v33, v33
    v_mfma_f32_32x32x16_bf16 v[40:55], v[140:143], v[100:103], v[40:55]
    buffer_load_dwordx4 v[128:131], v2, s[44:47], s55 offen offset:2048
    buffer_load_dwordx4 v[132:135], v2, s[44:47], s55 offen offset:3072
    buffer_load_dwordx4 v[136:139], v1, s[44:47], s56 offen
    buffer_load_dwordx3 v[140:142], v152, s[44:47], s56 offen offset:1024
    s_waitcnt vmcnt(8)
    v_cvt_pk_bf16_f32 v19, v30, v31
    v_exp_f32_e64 v34, v34
    v_exp_f32 v35, v35
    v_mfma_f32_32x32x16_bf16 v[56:71], v[144:147], v[16:19], v[56:71]
    v_cvt_pk_bf16_f32 v20, v32, v33
    v_exp_f32 v36, v36
    v_exp_f32 v37, v37
    v_cvt_pk_bf16_f32 v21, v34, v35
    v_exp_f32 v38, v38
    v_exp_f32 v39, v39
    v_cvt_pk_bf16_f32 v22, v36, v37
    v_cvt_pk_bf16_f32 v23, v38, v39
    s_setprio 1
    v_exp_f32_e64 v40, v40
    v_exp_f32 v41, v41
    v_mfma_f32_32x32x16_bf16 v[56:71], v[148:151], v[20:23], v[56:71]
    v_exp_f32 v42, v42
    v_exp_f32 v43, v43
    v_cvt_pk_bf16_f32 v16, v40, v41
    v_exp_f32 v44, v44
    v_exp_f32 v45, v45
    v_mfma_f32_32x32x16_bf16 v[24:39], v[104:107], v[88:91], 0
    v_cvt_pk_bf16_f32 v17, v42, v43
    v_exp_f32 v46, v46
    v_exp_f32 v47, v47
    v_cvt_pk_bf16_f32 v18, v44, v45
    v_exp_f32 v48, v48
    v_exp_f32 v49, v49
    v_mfma_f32_32x32x16_bf16 v[24:39], v[108:111], v[92:95], v[24:39]
    v_cvt_pk_bf16_f32 v19, v46, v47
    v_exp_f32 v50, v50
    v_exp_f32 v51, v51
    v_mfma_f32_32x32x16_bf16 v[72:87], v[144:147], v[16:19], v[72:87]
    v_cvt_pk_bf16_f32 v20, v48, v49
    v_exp_f32 v52, v52
    v_exp_f32 v53, v53
    v_cvt_pk_bf16_f32 v21, v50, v51
    v_exp_f32 v54, v54
    v_exp_f32 v55, v55
    v_cvt_pk_bf16_f32 v22, v52, v53
    v_cvt_pk_bf16_f32 v23, v54, v55
    s_setprio 2
    v_exp_f32_e64 v24, v24
    v_exp_f32 v25, v25
    v_mfma_f32_32x32x16_bf16 v[72:87], v[148:151], v[20:23], v[72:87]
    v_exp_f32 v26, v26
    v_exp_f32 v27, v27
    v_cvt_pk_bf16_f32 v16, v24, v25
    v_exp_f32 v28, v28
    v_exp_f32 v29, v29
    v_mfma_f32_32x32x16_bf16 v[40:55], v[104:107], v[96:99], 0
    v_cvt_pk_bf16_f32 v17, v26, v27
    v_exp_f32 v30, v30
    v_exp_f32 v31, v31
    v_cvt_pk_bf16_f32 v18, v28, v29
    v_exp_f32 v32, v32
    v_exp_f32 v33, v33
    v_mfma_f32_32x32x16_bf16 v[40:55], v[108:111], v[100:103], v[40:55]
    buffer_load_dwordx4 v[144:147], v2, s[44:47], s56 offen offset:2048
    buffer_load_dwordx4 v[148:151], v2, s[44:47], s56 offen offset:3072
    buffer_load_dwordx4 v[104:107], v1, s[44:47], s57 offen
    buffer_load_dwordx3 v[108:110], v152, s[44:47], s57 offen offset:1024
    s_waitcnt vmcnt(8)
    v_cvt_pk_bf16_f32 v19, v30, v31
    v_exp_f32_e64 v34, v34
    v_exp_f32 v35, v35
    v_mfma_f32_32x32x16_bf16 v[56:71], v[112:115], v[16:19], v[56:71]
    v_cvt_pk_bf16_f32 v20, v32, v33
    v_exp_f32 v36, v36
    v_exp_f32 v37, v37
    v_cvt_pk_bf16_f32 v21, v34, v35
    v_exp_f32 v38, v38
    v_exp_f32 v39, v39
    v_cvt_pk_bf16_f32 v22, v36, v37
    v_cvt_pk_bf16_f32 v23, v38, v39
    s_setprio 1
    v_exp_f32_e64 v40, v40
    v_exp_f32 v41, v41
    v_mfma_f32_32x32x16_bf16 v[56:71], v[116:119], v[20:23], v[56:71]
    v_exp_f32 v42, v42
    v_exp_f32 v43, v43
    v_cvt_pk_bf16_f32 v16, v40, v41
    v_exp_f32 v44, v44
    v_exp_f32 v45, v45
    v_mfma_f32_32x32x16_bf16 v[24:39], v[120:123], v[88:91], 0
    v_cvt_pk_bf16_f32 v17, v42, v43
    v_exp_f32 v46, v46
    v_exp_f32 v47, v47
    v_cvt_pk_bf16_f32 v18, v44, v45
    v_exp_f32 v48, v48
    v_exp_f32 v49, v49
    v_mfma_f32_32x32x16_bf16 v[24:39], v[124:127], v[92:95], v[24:39]
    v_cvt_pk_bf16_f32 v19, v46, v47
    v_exp_f32 v50, v50
    v_exp_f32 v51, v51
    v_mfma_f32_32x32x16_bf16 v[72:87], v[112:115], v[16:19], v[72:87]
    v_cvt_pk_bf16_f32 v20, v48, v49
    v_exp_f32 v52, v52
    v_exp_f32 v53, v53
    v_cvt_pk_bf16_f32 v21, v50, v51
    v_exp_f32 v54, v54
    v_exp_f32 v55, v55
    v_cvt_pk_bf16_f32 v22, v52, v53
    v_cvt_pk_bf16_f32 v23, v54, v55
    s_setprio 2
    v_exp_f32_e64 v24, v24
    v_exp_f32 v25, v25
    v_mfma_f32_32x32x16_bf16 v[72:87], v[116:119], v[20:23], v[72:87]
    v_exp_f32 v26, v26
    v_exp_f32 v27, v27
    v_cvt_pk_bf16_f32 v16, v24, v25
    v_exp_f32 v28, v28
    v_exp_f32 v29, v29
    v_mfma_f32_32x32x16_bf16 v[40:55], v[120:123], v[96:99], 0
    v_cvt_pk_bf16_f32 v17, v26, v27
    v_exp_f32 v30, v30
    v_exp_f32 v31, v31
    v_cvt_pk_bf16_f32 v18, v28, v29
    v_exp_f32 v32, v32
    v_exp_f32 v33, v33
    v_mfma_f32_32x32x16_bf16 v[40:55], v[124:127], v[100:103], v[40:55]
    buffer_load_dwordx4 v[112:115], v2, s[44:47], s57 offen offset:2048
    buffer_load_dwordx4 v[116:119], v2, s[44:47], s57 offen offset:3072
    buffer_load_dwordx4 v[120:123], v1, s[44:47], s58 offen
    buffer_load_dwordx3 v[124:126], v152, s[44:47], s58 offen offset:1024
    s_waitcnt vmcnt(8)
    v_cvt_pk_bf16_f32 v19, v30, v31
    v_exp_f32_e64 v34, v34
    v_exp_f32 v35, v35
    v_mfma_f32_32x32x16_bf16 v[56:71], v[128:131], v[16:19], v[56:71]
    v_cvt_pk_bf16_f32 v20, v32, v33
    v_exp_f32 v36, v36
    v_exp_f32 v37, v37
    v_cvt_pk_bf16_f32 v21, v34, v35
    v_exp_f32 v38, v38
    v_exp_f32 v39, v39
    v_cvt_pk_bf16_f32 v22, v36, v37
    v_cvt_pk_bf16_f32 v23, v38, v39
    s_setprio 1
    v_exp_f32_e64 v40, v40
    v_exp_f32 v41, v41
    v_mfma_f32_32x32x16_bf16 v[56:71], v[132:135], v[20:23], v[56:71]
    v_exp_f32 v42, v42
    v_exp_f32 v43, v43
    v_cvt_pk_bf16_f32 v16, v40, v41
    v_exp_f32 v44, v44
    v_exp_f32 v45, v45
    v_mfma_f32_32x32x16_bf16 v[24:39], v[136:139], v[88:91], 0
    v_cvt_pk_bf16_f32 v17, v42, v43
    v_exp_f32 v46, v46
    v_exp_f32 v47, v47
    v_cvt_pk_bf16_f32 v18, v44, v45
    v_exp_f32 v48, v48
    v_exp_f32 v49, v49
    v_mfma_f32_32x32x16_bf16 v[24:39], v[140:143], v[92:95], v[24:39]
    v_cvt_pk_bf16_f32 v19, v46, v47
    v_exp_f32 v50, v50
    v_exp_f32 v51, v51
    v_mfma_f32_32x32x16_bf16 v[72:87], v[128:131], v[16:19], v[72:87]
    v_cvt_pk_bf16_f32 v20, v48, v49
    v_exp_f32 v52, v52
    v_exp_f32 v53, v53
    v_cvt_pk_bf16_f32 v21, v50, v51
    v_exp_f32 v54, v54
    v_exp_f32 v55, v55
    v_cvt_pk_bf16_f32 v22, v52, v53
    v_cvt_pk_bf16_f32 v23, v54, v55
    s_setprio 2
    v_exp_f32_e64 v24, v24
    v_exp_f32 v25, v25
    v_mfma_f32_32x32x16_bf16 v[72:87], v[132:135], v[20:23], v[72:87]
    v_exp_f32 v26, v26
    v_exp_f32 v27, v27
    v_cvt_pk_bf16_f32 v16, v24, v25
    v_exp_f32 v28, v28
    v_exp_f32 v29, v29
    v_mfma_f32_32x32x16_bf16 v[40:55], v[136:139], v[96:99], 0
    v_cvt_pk_bf16_f32 v17, v26, v27
    v_exp_f32 v30, v30
    v_exp_f32 v31, v31
    v_cvt_pk_bf16_f32 v18, v28, v29
    v_exp_f32 v32, v32
    v_exp_f32 v33, v33
    v_mfma_f32_32x32x16_bf16 v[40:55], v[140:143], v[100:103], v[40:55]
    buffer_load_dwordx4 v[128:131], v2, s[44:47], s58 offen offset:2048
    buffer_load_dwordx4 v[132:135], v2, s[44:47], s58 offen offset:3072
    buffer_load_dwordx4 v[136:139], v1, s[44:47], s59 offen
    buffer_load_dwordx3 v[140:142], v152, s[44:47], s59 offen offset:1024
    s_waitcnt vmcnt(8)
    v_cvt_pk_bf16_f32 v19, v30, v31
    v_exp_f32_e64 v34, v34
    v_exp_f32 v35, v35
    v_mfma_f32_32x32x16_bf16 v[56:71], v[144:147], v[16:19], v[56:71]
    v_cvt_pk_bf16_f32 v20, v32, v33
    v_exp_f32 v36, v36
    v_exp_f32 v37, v37
    v_cvt_pk_bf16_f32 v21, v34, v35
    v_exp_f32 v38, v38
    v_exp_f32 v39, v39
    v_cvt_pk_bf16_f32 v22, v36, v37
    v_cvt_pk_bf16_f32 v23, v38, v39
    s_setprio 1
    v_exp_f32_e64 v40, v40
    v_exp_f32 v41, v41
    v_mfma_f32_32x32x16_bf16 v[56:71], v[148:151], v[20:23], v[56:71]
    v_exp_f32 v42, v42
    v_exp_f32 v43, v43
    v_cvt_pk_bf16_f32 v16, v40, v41
    v_exp_f32 v44, v44
    v_exp_f32 v45, v45
    v_mfma_f32_32x32x16_bf16 v[24:39], v[104:107], v[88:91], 0
    v_cvt_pk_bf16_f32 v17, v42, v43
    v_exp_f32 v46, v46
    v_exp_f32 v47, v47
    v_cvt_pk_bf16_f32 v18, v44, v45
    v_exp_f32 v48, v48
    v_exp_f32 v49, v49
    v_mfma_f32_32x32x16_bf16 v[24:39], v[108:111], v[92:95], v[24:39]
    v_cvt_pk_bf16_f32 v19, v46, v47
    v_exp_f32 v50, v50
    v_exp_f32 v51, v51
    v_mfma_f32_32x32x16_bf16 v[72:87], v[144:147], v[16:19], v[72:87]
    v_cvt_pk_bf16_f32 v20, v48, v49
    v_exp_f32 v52, v52
    v_exp_f32 v53, v53
    v_cvt_pk_bf16_f32 v21, v50, v51
    v_exp_f32 v54, v54
    v_exp_f32 v55, v55
    v_cvt_pk_bf16_f32 v22, v52, v53
    v_cvt_pk_bf16_f32 v23, v54, v55
    s_setprio 2
    v_exp_f32_e64 v24, v24
    v_exp_f32 v25, v25
    v_mfma_f32_32x32x16_bf16 v[72:87], v[148:151], v[20:23], v[72:87]
    v_exp_f32 v26, v26
    v_exp_f32 v27, v27
    v_cvt_pk_bf16_f32 v16, v24, v25
    v_exp_f32 v28, v28
    v_exp_f32 v29, v29
    v_mfma_f32_32x32x16_bf16 v[40:55], v[104:107], v[96:99], 0
    v_cvt_pk_bf16_f32 v17, v26, v27
    v_exp_f32 v30, v30
    v_exp_f32 v31, v31
    v_cvt_pk_bf16_f32 v18, v28, v29
    v_exp_f32 v32, v32
    v_exp_f32 v33, v33
    v_mfma_f32_32x32x16_bf16 v[40:55], v[108:111], v[100:103], v[40:55]
    buffer_load_dwordx4 v[144:147], v2, s[44:47], s59 offen offset:2048
    buffer_load_dwordx4 v[148:151], v2, s[44:47], s59 offen offset:3072
    buffer_load_dwordx4 v[104:107], v1, s[44:47], s60 offen
    buffer_load_dwordx3 v[108:110], v152, s[44:47], s60 offen offset:1024
    s_waitcnt vmcnt(8)
    v_cvt_pk_bf16_f32 v19, v30, v31
    v_exp_f32_e64 v34, v34
    v_exp_f32 v35, v35
    v_mfma_f32_32x32x16_bf16 v[56:71], v[112:115], v[16:19], v[56:71]
    v_cvt_pk_bf16_f32 v20, v32, v33
    v_exp_f32 v36, v36
    v_exp_f32 v37, v37
    v_cvt_pk_bf16_f32 v21, v34, v35
    v_exp_f32 v38, v38
    v_exp_f32 v39, v39
    v_cvt_pk_bf16_f32 v22, v36, v37
    v_cvt_pk_bf16_f32 v23, v38, v39
    s_setprio 1
    v_exp_f32_e64 v40, v40
    v_exp_f32 v41, v41
    v_mfma_f32_32x32x16_bf16 v[56:71], v[116:119], v[20:23], v[56:71]
    v_exp_f32 v42, v42
    v_exp_f32 v43, v43
    v_cvt_pk_bf16_f32 v16, v40, v41
    v_exp_f32 v44, v44
    v_exp_f32 v45, v45
    v_mfma_f32_32x32x16_bf16 v[24:39], v[120:123], v[88:91], 0
    v_cvt_pk_bf16_f32 v17, v42, v43
    v_exp_f32 v46, v46
    v_exp_f32 v47, v47
    v_cvt_pk_bf16_f32 v18, v44, v45
    v_exp_f32 v48, v48
    v_exp_f32 v49, v49
    v_mfma_f32_32x32x16_bf16 v[24:39], v[124:127], v[92:95], v[24:39]
    v_cvt_pk_bf16_f32 v19, v46, v47
    v_exp_f32 v50, v50
    v_exp_f32 v51, v51
    v_mfma_f32_32x32x16_bf16 v[72:87], v[112:115], v[16:19], v[72:87]
    v_cvt_pk_bf16_f32 v20, v48, v49
    v_exp_f32 v52, v52
    v_exp_f32 v53, v53
    v_cvt_pk_bf16_f32 v21, v50, v51
    v_exp_f32 v54, v54
    v_exp_f32 v55, v55
    v_cvt_pk_bf16_f32 v22, v52, v53
    v_cvt_pk_bf16_f32 v23, v54, v55
    s_setprio 2
    v_exp_f32_e64 v24, v24
    v_exp_f32 v25, v25
    v_mfma_f32_32x32x16_bf16 v[72:87], v[116:119], v[20:23], v[72:87]
    v_exp_f32 v26, v26
    v_exp_f32 v27, v27
    v_cvt_pk_bf16_f32 v16, v24, v25
    v_exp_f32 v28, v28
    v_exp_f32 v29, v29
    v_mfma_f32_32x32x16_bf16 v[40:55], v[120:123], v[96:99], 0
    v_cvt_pk_bf16_f32 v17, v26, v27
    v_exp_f32 v30, v30
    v_exp_f32 v31, v31
    v_cvt_pk_bf16_f32 v18, v28, v29
    v_exp_f32 v32, v32
    v_exp_f32 v33, v33
    v_mfma_f32_32x32x16_bf16 v[40:55], v[124:127], v[100:103], v[40:55]
    buffer_load_dwordx4 v[112:115], v2, s[44:47], s60 offen offset:2048
    buffer_load_dwordx4 v[116:119], v2, s[44:47], s60 offen offset:3072
    buffer_load_dwordx4 v[120:123], v1, s[44:47], s61 offen
    buffer_load_dwordx3 v[124:126], v152, s[44:47], s61 offen offset:1024
    s_waitcnt vmcnt(8)
    v_cvt_pk_bf16_f32 v19, v30, v31
    v_exp_f32_e64 v34, v34
    v_exp_f32 v35, v35
    v_mfma_f32_32x32x16_bf16 v[56:71], v[128:131], v[16:19], v[56:71]
    v_cvt_pk_bf16_f32 v20, v32, v33
    v_exp_f32 v36, v36
    v_exp_f32 v37, v37
    v_cvt_pk_bf16_f32 v21, v34, v35
    v_exp_f32 v38, v38
    v_exp_f32 v39, v39
    v_cvt_pk_bf16_f32 v22, v36, v37
    v_cvt_pk_bf16_f32 v23, v38, v39
    s_setprio 1
    v_exp_f32_e64 v40, v40
    v_exp_f32 v41, v41
    v_mfma_f32_32x32x16_bf16 v[56:71], v[132:135], v[20:23], v[56:71]
    v_exp_f32 v42, v42
    v_exp_f32 v43, v43
    v_cvt_pk_bf16_f32 v16, v40, v41
    v_exp_f32 v44, v44
    v_exp_f32 v45, v45
    v_mfma_f32_32x32x16_bf16 v[24:39], v[136:139], v[88:91], 0
    v_cvt_pk_bf16_f32 v17, v42, v43
    v_exp_f32 v46, v46
    v_exp_f32 v47, v47
    v_cvt_pk_bf16_f32 v18, v44, v45
    v_exp_f32 v48, v48
    v_exp_f32 v49, v49
    v_mfma_f32_32x32x16_bf16 v[24:39], v[140:143], v[92:95], v[24:39]
    v_cvt_pk_bf16_f32 v19, v46, v47
    v_exp_f32 v50, v50
    v_exp_f32 v51, v51
    v_mfma_f32_32x32x16_bf16 v[72:87], v[128:131], v[16:19], v[72:87]
    v_cvt_pk_bf16_f32 v20, v48, v49
    v_exp_f32 v52, v52
    v_exp_f32 v53, v53
    v_cvt_pk_bf16_f32 v21, v50, v51
    v_exp_f32 v54, v54
    v_exp_f32 v55, v55
    v_cvt_pk_bf16_f32 v22, v52, v53
    v_cvt_pk_bf16_f32 v23, v54, v55
    s_setprio 2
    v_exp_f32_e64 v24, v24
    v_exp_f32 v25, v25
    v_mfma_f32_32x32x16_bf16 v[72:87], v[132:135], v[20:23], v[72:87]
    v_exp_f32 v26, v26
    v_exp_f32 v27, v27
    v_cvt_pk_bf16_f32 v16, v24, v25
    v_exp_f32 v28, v28
    v_exp_f32 v29, v29
    v_mfma_f32_32x32x16_bf16 v[40:55], v[136:139], v[96:99], 0
    v_cvt_pk_bf16_f32 v17, v26, v27
    v_exp_f32 v30, v30
    v_exp_f32 v31, v31
    v_cvt_pk_bf16_f32 v18, v28, v29
    v_exp_f32 v32, v32
    v_exp_f32 v33, v33
    v_mfma_f32_32x32x16_bf16 v[40:55], v[140:143], v[100:103], v[40:55]
    buffer_load_dwordx4 v[128:131], v2, s[44:47], s61 offen offset:2048
    buffer_load_dwordx4 v[132:135], v2, s[44:47], s61 offen offset:3072
    buffer_load_dwordx4 v[136:139], v1, s[44:47], s62 offen
    buffer_load_dwordx3 v[140:142], v152, s[44:47], s62 offen offset:1024
    s_waitcnt vmcnt(8)
    v_cvt_pk_bf16_f32 v19, v30, v31
    v_exp_f32_e64 v34, v34
    v_exp_f32 v35, v35
    v_mfma_f32_32x32x16_bf16 v[56:71], v[144:147], v[16:19], v[56:71]
    v_cvt_pk_bf16_f32 v20, v32, v33
    v_exp_f32 v36, v36
    v_exp_f32 v37, v37
    v_cvt_pk_bf16_f32 v21, v34, v35
    v_exp_f32 v38, v38
    v_exp_f32 v39, v39
    v_cvt_pk_bf16_f32 v22, v36, v37
    v_cvt_pk_bf16_f32 v23, v38, v39
    s_setprio 1
    v_exp_f32_e64 v40, v40
    v_exp_f32 v41, v41
    v_mfma_f32_32x32x16_bf16 v[56:71], v[148:151], v[20:23], v[56:71]
    v_exp_f32 v42, v42
    v_exp_f32 v43, v43
    v_cvt_pk_bf16_f32 v16, v40, v41
    v_exp_f32 v44, v44
    v_exp_f32 v45, v45
    v_mfma_f32_32x32x16_bf16 v[24:39], v[104:107], v[88:91], 0
    v_cvt_pk_bf16_f32 v17, v42, v43
    v_exp_f32 v46, v46
    v_exp_f32 v47, v47
    v_cvt_pk_bf16_f32 v18, v44, v45
    v_exp_f32 v48, v48
    v_exp_f32 v49, v49
    v_mfma_f32_32x32x16_bf16 v[24:39], v[108:111], v[92:95], v[24:39]
    v_cvt_pk_bf16_f32 v19, v46, v47
    v_exp_f32 v50, v50
    v_exp_f32 v51, v51
    v_mfma_f32_32x32x16_bf16 v[72:87], v[144:147], v[16:19], v[72:87]
    v_cvt_pk_bf16_f32 v20, v48, v49
    v_exp_f32 v52, v52
    v_exp_f32 v53, v53
    v_cvt_pk_bf16_f32 v21, v50, v51
    v_exp_f32 v54, v54
    v_exp_f32 v55, v55
    v_cvt_pk_bf16_f32 v22, v52, v53
    v_cvt_pk_bf16_f32 v23, v54, v55
    s_setprio 2
    v_exp_f32_e64 v24, v24
    v_exp_f32 v25, v25
    v_mfma_f32_32x32x16_bf16 v[72:87], v[148:151], v[20:23], v[72:87]
    v_exp_f32 v26, v26
    v_exp_f32 v27, v27
    v_cvt_pk_bf16_f32 v16, v24, v25
    v_exp_f32 v28, v28
    v_exp_f32 v29, v29
    v_mfma_f32_32x32x16_bf16 v[40:55], v[104:107], v[96:99], 0
    v_cvt_pk_bf16_f32 v17, v26, v27
    v_exp_f32 v30, v30
    v_exp_f32 v31, v31
    v_cvt_pk_bf16_f32 v18, v28, v29
    v_exp_f32 v32, v32
    v_exp_f32 v33, v33
    v_mfma_f32_32x32x16_bf16 v[40:55], v[108:111], v[100:103], v[40:55]
    buffer_load_dwordx4 v[144:147], v2, s[44:47], s62 offen offset:2048
    buffer_load_dwordx4 v[148:151], v2, s[44:47], s62 offen offset:3072
    buffer_load_dwordx4 v[104:107], v1, s[44:47], s63 offen
    buffer_load_dwordx3 v[108:110], v152, s[44:47], s63 offen offset:1024
    s_waitcnt vmcnt(8)
    v_cvt_pk_bf16_f32 v19, v30, v31
    v_exp_f32_e64 v34, v34
    v_exp_f32 v35, v35
    v_mfma_f32_32x32x16_bf16 v[56:71], v[112:115], v[16:19], v[56:71]
    v_cvt_pk_bf16_f32 v20, v32, v33
    v_exp_f32 v36, v36
    v_exp_f32 v37, v37
    v_cvt_pk_bf16_f32 v21, v34, v35
    v_exp_f32 v38, v38
    v_exp_f32 v39, v39
    v_cvt_pk_bf16_f32 v22, v36, v37
    v_cvt_pk_bf16_f32 v23, v38, v39
    s_setprio 1
    v_exp_f32_e64 v40, v40
    v_exp_f32 v41, v41
    v_mfma_f32_32x32x16_bf16 v[56:71], v[116:119], v[20:23], v[56:71]
    ds_read_b32 v158, v159 offset:128
    v_exp_f32 v42, v42
    v_exp_f32 v43, v43
    v_cvt_pk_bf16_f32 v16, v40, v41
    v_exp_f32 v44, v44
    v_exp_f32 v45, v45
    v_mfma_f32_32x32x16_bf16 v[24:39], v[120:123], v[88:91], 0
    v_cvt_pk_bf16_f32 v17, v42, v43
    v_exp_f32 v46, v46
    v_exp_f32 v47, v47
    v_cvt_pk_bf16_f32 v18, v44, v45
    v_exp_f32 v48, v48
    v_exp_f32 v49, v49
    v_mfma_f32_32x32x16_bf16 v[24:39], v[124:127], v[92:95], v[24:39]
    v_cvt_pk_bf16_f32 v19, v46, v47
    v_exp_f32 v50, v50
    v_exp_f32 v51, v51
    v_mfma_f32_32x32x16_bf16 v[72:87], v[112:115], v[16:19], v[72:87]
    v_cvt_pk_bf16_f32 v20, v48, v49
    v_exp_f32 v52, v52
    v_exp_f32 v53, v53
    v_cvt_pk_bf16_f32 v21, v50, v51
    v_exp_f32 v54, v54
    v_exp_f32 v55, v55
    v_cvt_pk_bf16_f32 v22, v52, v53
    v_cvt_pk_bf16_f32 v23, v54, v55
    s_setprio 2
    v_exp_f32_e64 v24, v24
    v_exp_f32 v25, v25
    v_mfma_f32_32x32x16_bf16 v[72:87], v[116:119], v[20:23], v[72:87]
    v_exp_f32 v26, v26
    v_exp_f32 v27, v27
    v_cvt_pk_bf16_f32 v16, v24, v25
    v_exp_f32 v28, v28
    v_exp_f32 v29, v29
    v_mfma_f32_32x32x16_bf16 v[40:55], v[120:123], v[96:99], 0
    v_cvt_pk_bf16_f32 v17, v26, v27
    v_exp_f32 v30, v30
    v_exp_f32 v31, v31
    v_cvt_pk_bf16_f32 v18, v28, v29
    v_exp_f32 v32, v32
    v_exp_f32 v33, v33
    v_mfma_f32_32x32x16_bf16 v[40:55], v[124:127], v[100:103], v[40:55]
    buffer_load_dwordx4 v[112:115], v2, s[44:47], s63 offen offset:2048
    buffer_load_dwordx4 v[116:119], v2, s[44:47], s63 offen offset:3072
    s_waitcnt vmcnt(6)
    v_cvt_pk_bf16_f32 v19, v30, v31
    v_exp_f32_e64 v34, v34
    v_exp_f32 v35, v35
    v_mfma_f32_32x32x16_bf16 v[56:71], v[128:131], v[16:19], v[56:71]
    v_cvt_pk_bf16_f32 v20, v32, v33
    v_exp_f32 v36, v36
    v_exp_f32 v37, v37
    v_cvt_pk_bf16_f32 v21, v34, v35
    v_exp_f32 v38, v38
    v_exp_f32 v39, v39
    v_cvt_pk_bf16_f32 v22, v36, v37
    v_cvt_pk_bf16_f32 v23, v38, v39
    s_setprio 1
    v_exp_f32_e64 v40, v40
    v_exp_f32 v41, v41
    v_mfma_f32_32x32x16_bf16 v[56:71], v[132:135], v[20:23], v[56:71]
    s_waitcnt lgkmcnt(0)
    v_readfirstlane_b32 s70, v158
    s_cmp_lt_u32 s70, 4
    s_cbranch_scc1 L_WDW
L_WDB:
    s_mov_b64 exec, 1
    ds_add_u32 v159, v163 offset:132
    s_mov_b64 exec, -1
    v_exp_f32 v42, v42
    v_exp_f32 v43, v43
    v_cvt_pk_bf16_f32 v16, v40, v41
    v_exp_f32 v44, v44
    v_exp_f32 v45, v45
    v_mfma_f32_32x32x16_bf16 v[24:39], v[136:139], v[88:91], 0
    v_cvt_pk_bf16_f32 v17, v42, v43
    v_exp_f32 v46, v46
    v_exp_f32 v47, v47
    v_cvt_pk_bf16_f32 v18, v44, v45
    v_exp_f32 v48, v48
    v_exp_f32 v49, v49
    v_mfma_f32_32x32x16_bf16 v[24:39], v[140:143], v[92:95], v[24:39]
    v_cvt_pk_bf16_f32 v19, v46, v47
    v_exp_f32 v50, v50
    v_exp_f32 v51, v51
    v_mfma_f32_32x32x16_bf16 v[72:87], v[128:131], v[16:19], v[72:87]
    v_cvt_pk_bf16_f32 v20, v48, v49
    v_exp_f32 v52, v52
    v_exp_f32 v53, v53
    v_cvt_pk_bf16_f32 v21, v50, v51
    v_exp_f32 v54, v54
    v_exp_f32 v55, v55
    v_cvt_pk_bf16_f32 v22, v52, v53
    v_cvt_pk_bf16_f32 v23, v54, v55
    s_setprio 2
    v_exp_f32_e64 v24, v24
    v_exp_f32 v25, v25
    v_mfma_f32_32x32x16_bf16 v[72:87], v[132:135], v[20:23], v[72:87]
    v_exp_f32 v26, v26
    v_exp_f32 v27, v27
    v_cvt_pk_bf16_f32 v16, v24, v25
    v_exp_f32 v28, v28
    v_exp_f32 v29, v29
    v_mfma_f32_32x32x16_bf16 v[40:55], v[136:139], v[96:99], 0
    v_cvt_pk_bf16_f32 v17, v26, v27
    v_exp_f32 v30, v30
    v_exp_f32 v31, v31
    v_cvt_pk_bf16_f32 v18, v28, v29
    v_exp_f32 v32, v32
    v_exp_f32 v33, v33
    v_mfma_f32_32x32x16_bf16 v[40:55], v[140:143], v[100:103], v[40:55]
    s_waitcnt vmcnt(2)
    v_cvt_pk_bf16_f32 v19, v30, v31
    v_exp_f32_e64 v34, v34
    v_exp_f32 v35, v35
    v_mfma_f32_32x32x16_bf16 v[56:71], v[144:147], v[16:19], v[56:71]
    v_cvt_pk_bf16_f32 v20, v32, v33
    v_exp_f32 v36, v36
    v_exp_f32 v37, v37
    v_cvt_pk_bf16_f32 v21, v34, v35
    v_exp_f32 v38, v38
    v_exp_f32 v39, v39
    v_cvt_pk_bf16_f32 v22, v36, v37
    v_cvt_pk_bf16_f32 v23, v38, v39
    s_setprio 1
    v_exp_f32_e64 v40, v40
    v_exp_f32 v41, v41
    v_mfma_f32_32x32x16_bf16 v[56:71], v[148:151], v[20:23], v[56:71]
    ds_read_b32 v158, v159 offset:92
    v_exp_f32 v42, v42
    v_exp_f32 v43, v43
    v_cvt_pk_bf16_f32 v16, v40, v41
    v_exp_f32 v44, v44
    v_exp_f32 v45, v45
    v_mfma_f32_32x32x16_bf16 v[24:39], v[104:107], v[88:91], 0
    v_cvt_pk_bf16_f32 v17, v42, v43
    v_exp_f32 v46, v46
    v_exp_f32 v47, v47
    v_cvt_pk_bf16_f32 v18, v44, v45
    v_exp_f32 v48, v48
    v_exp_f32 v49, v49
    v_mfma_f32_32x32x16_bf16 v[24:39], v[108:111], v[92:95], v[24:39]
    v_cvt_pk_bf16_f32 v19, v46, v47
    v_exp_f32 v50, v50
    v_exp_f32 v51, v51
    v_mfma_f32_32x32x16_bf16 v[72:87], v[144:147], v[16:19], v[72:87]
    v_cvt_pk_bf16_f32 v20, v48, v49
    v_exp_f32 v52, v52
    v_exp_f32 v53, v53
    v_cvt_pk_bf16_f32 v21, v50, v51
    v_exp_f32 v54, v54
    v_exp_f32 v55, v55
    v_cvt_pk_bf16_f32 v22, v52, v53
    v_cvt_pk_bf16_f32 v23, v54, v55
    s_setprio 2
    v_exp_f32_e64 v24, v24
    v_exp_f32 v25, v25
    v_mfma_f32_32x32x16_bf16 v[72:87], v[148:151], v[20:23], v[72:87]
    v_exp_f32 v26, v26
    v_exp_f32 v27, v27
    v_cvt_pk_bf16_f32 v16, v24, v25
    v_exp_f32 v28, v28
    v_exp_f32 v29, v29
    v_mfma_f32_32x32x16_bf16 v[40:55], v[104:107], v[96:99], 0
    v_cvt_pk_bf16_f32 v17, v26, v27
    v_exp_f32 v30, v30
    v_exp_f32 v31, v31
    v_cvt_pk_bf16_f32 v18, v28, v29
    v_exp_f32 v32, v32
    v_exp_f32 v33, v33
    v_mfma_f32_32x32x16_bf16 v[40:55], v[108:111], v[100:103], v[40:55]
    s_waitcnt vmcnt(0)
    v_cvt_pk_bf16_f32 v19, v30, v31
    v_exp_f32_e64 v34, v34
    v_exp_f32 v35, v35
    v_mfma_f32_32x32x16_bf16 v[56:71], v[112:115], v[16:19], v[56:71]
    v_cvt_pk_bf16_f32 v20, v32, v33
    v_exp_f32 v36, v36
    v_exp_f32 v37, v37
    v_cvt_pk_bf16_f32 v21, v34, v35
    v_exp_f32 v38, v38
    v_exp_f32 v39, v39
    v_cvt_pk_bf16_f32 v22, v36, v37
    v_cvt_pk_bf16_f32 v23, v38, v39
    s_setprio 1
    v_exp_f32_e64 v40, v40
    v_exp_f32 v41, v41
    v_mfma_f32_32x32x16_bf16 v[56:71], v[116:119], v[20:23], v[56:71]
    v_exp_f32 v42, v42
    v_exp_f32 v43, v43
    v_cvt_pk_bf16_f32 v16, v40, v41
    v_exp_f32 v44, v44
    v_exp_f32 v45, v45
    v_cvt_pk_bf16_f32 v17, v42, v43
    v_exp_f32 v46, v46
    v_exp_f32 v47, v47
    v_cvt_pk_bf16_f32 v18, v44, v45
    v_exp_f32 v48, v48
    v_exp_f32 v49, v49
    v_cvt_pk_bf16_f32 v19, v46, v47
    v_exp_f32 v50, v50
    v_exp_f32 v51, v51
    v_mfma_f32_32x32x16_bf16 v[72:87], v[112:115], v[16:19], v[72:87]
    v_cvt_pk_bf16_f32 v20, v48, v49
    v_exp_f32 v52, v52
    v_exp_f32 v53, v53
    v_cvt_pk_bf16_f32 v21, v50, v51
    v_exp_f32 v54, v54
    v_exp_f32 v55, v55
    v_cvt_pk_bf16_f32 v22, v52, v53
    v_cvt_pk_bf16_f32 v23, v54, v55
    s_nop 1
    v_mfma_f32_32x32x16_bf16 v[72:87], v[116:119], v[20:23], v[72:87]
    s_setprio 0
    v_cvt_pk_bf16_f32 v24, v64, v65
    v_cvt_pk_bf16_f32 v25, v66, v67
    v_cvt_pk_bf16_f32 v26, v68, v69
    v_cvt_pk_bf16_f32 v27, v70, v71
    v_cndmask_b32 v17, v60, v68, s[96:97]
    ds_write_b128 v160, v[24:27]
    s_mov_b32 exec_lo, 0
    s_mov_b32 exec_hi, -1
    ds_write_b32 v9, v17
    s_mov_b64 exec, -1
    s_mov_b32 s68, 0x00003f80
    s_mov_b32 s69, 0x3f800000
    v_cvt_pk_bf16_f32 v28, v72, v73
    v_cvt_pk_bf16_f32 v29, v74, v75
    v_cvt_pk_bf16_f32 v30, v76, v77
    v_cvt_pk_bf16_f32 v31, v78, v79
    v_cvt_pk_bf16_f32 v32, v80, v81
    v_cvt_pk_bf16_f32 v33, v82, v83
    v_cvt_pk_bf16_f32 v34, v84, v85
    v_cvt_pk_bf16_f32 v35, v86, v87
    v_cndmask_b32 v18, v76, v84, s[96:97]
    ds_write_b128 v161, v[28:31]
    ds_write_b128 v6, v[32:35]
    s_mov_b32 exec_lo, 0
    s_mov_b32 exec_hi, -1
    ds_write_b32 v10, v18
    s_mov_b64 exec, -1
    s_cmp_lt_u32 s3, 4
    s_cbranch_scc0 L_YNG
    s_getreg_b32 s13, hwreg(HW_REG_XCC_ID, 0, 4)
    s_xor_b32 s13, s13, s7
    s_mov_b32 s71, 60000
L_GP:
    buffer_load_dwordx2 v[150:151], v164, s[44:47], 0 offen sc1
    s_waitcnt vmcnt(0)
    v_cmp_ne_u32 vcc, s6, v150
    v_xor_b32 v17, s7, v151
    v_cmp_lt_u32 s[74:75], 15, v17
    s_nop 3
    s_or_b64 vcc, vcc, s[74:75]
    s_cbranch_scc0 L_GK
    s_sleep 8
    s_sub_u32 s71, s71, 1
    s_cbranch_scc0 L_GP
L_GK:
    v_cmp_ne_u32 vcc, s13, v151
    s_lshl_b32 s71, s3, 2
    v_add_u32 v17, s71, v159
    s_nop 2
    s_cmp_eq_u64 vcc, 0
    s_cselect_b32 s70, 1, 0
    v_mov_b32 v18, s70
    ds_write_b32 v17, v18 offset:144
    s_mov_b64 exec, 1
    ds_add_u32 v162, v163 offset:96
    s_mov_b64 exec, -1
    s_cmp_eq_u32 s5, 7
    s_cbranch_scc1 L_NOEA
    s_mov_b32 s52, s26
    s_mov_b32 s53, s27
    s_mov_b32 s54, 896
    s_mov_b32 s55, 0x20000
    s_add_u32 s70, s64, 4096
    buffer_load_dwordx4 v[104:107], v13, s[44:47], s64 offen sc1
    buffer_load_dwordx4 v[108:111], v13, s[44:47], s70 offen sc1
    buffer_load_dword v20, v14, s[52:55], s66 offen
    s_add_u32 s98, s65, 4096
    s_mov_b32 s71, 960000
L_LW_25:
    ds_read_b32 v17, v159 offset:132
    s_waitcnt lgkmcnt(0)
    v_readfirstlane_b32 s70, v17
    s_sub_u32 s71, s71, 1
    s_cbranch_scc1 L_LK_26
    s_cmp_ge_u32 s70, 8
    s_cbranch_scc1 L_LK_26
    s_sleep 2
    s_branch L_LW_25
L_LK_26:
    s_mov_b32 s13, 64
L_YE:
    buffer_load_dwordx4 v[112:115], v12, s[44:47], s65 offen sc1
    buffer_load_dwordx4 v[116:119], v12, s[44:47], s98 offen sc1
    s_mov_b32 s71, 5
L_YF:
    ds_read_b32 v17, v162 offset:96
    s_waitcnt lgkmcnt(0)
    v_readfirstlane_b32 s70, v17
    s_cmp_ge_u32 s70, 4
    s_cbranch_scc1 L_NOEA
    s_sleep 1
    s_sub_u32 s71, s71, 1
    s_cbranch_scc0 L_YF
    s_waitcnt vmcnt(0)
    v_max3_u32 v17, v112, v113, v114
    v_max3_u32 v18, v115, v116, v117
    v_max3_u32 v17, v17, v118, v119
    v_max_u32 v17, v17, v18
    v_cmp_eq_u32 vcc, -1, v17
    s_sub_u32 s13, s13, 1
    s_cbranch_scc1 L_NOEA
    s_nop 0
    s_cbranch_vccnz L_YE
    s_branch L_NOEA
L_YNG:
    s_mov_b64 exec, 1
    ds_add_u32 v162, v163 offset:96
    s_mov_b64 exec, -1
L_NOEA:
    s_mov_b32 s71, 960000
L_LW_27:
    ds_read_b32 v17, v162 offset:96
    s_waitcnt lgkmcnt(0)
    v_readfirstlane_b32 s70, v17
    s_sub_u32 s71, s71, 1
    s_cbranch_scc1 L_LK_28
    s_cmp_lt_u32 s70, 4
    s_cbranch_scc1 L_LW_27
L_LK_28:
    s_and_b32 s70, s3, 3
    s_lshl_b32 s70, s70, 2
    v_add_u32 v17, s70, v159
    ds_read_b32 v19, v17 offset:144
    ds_read_b128 v[36:39], v8
    ds_read_b128 v[24:27], v7
    ds_read_b128 v[28:31], v7 offset:1024
    ds_read_b128 v[32:35], v7 offset:2048
    s_waitcnt lgkmcnt(3)
    v_add_f32 v36, v36, v37
    v_add_f32 v38, v38, v39
    v_add_f32 v36, v36, v38
    v_rcp_f32 v36, v36
    s_waitcnt lgkmcnt(2)
    v_dot2_f32_bf16 v56, v24, s68, v56
    v_dot2_f32_bf16 v57, v24, s69, v57
    v_dot2_f32_bf16 v58, v25, s68, v58
    v_dot2_f32_bf16 v59, v25, s69, v59
    v_dot2_f32_bf16 v60, v26, s68, v60
    v_dot2_f32_bf16 v61, v26, s69, v61
    v_dot2_f32_bf16 v62, v27, s68, v62
    v_dot2_f32_bf16 v63, v27, s69, v63
    s_waitcnt lgkmcnt(1)
    v_dot2_f32_bf16 v56, v28, s68, v56
    v_dot2_f32_bf16 v57, v28, s69, v57
    v_dot2_f32_bf16 v58, v29, s68, v58
    v_dot2_f32_bf16 v59, v29, s69, v59
    v_dot2_f32_bf16 v60, v30, s68, v60
    v_dot2_f32_bf16 v61, v30, s69, v61
    v_dot2_f32_bf16 v62, v31, s68, v62
    v_dot2_f32_bf16 v63, v31, s69, v63
    s_waitcnt lgkmcnt(0)
    v_dot2_f32_bf16 v56, v32, s68, v56
    v_dot2_f32_bf16 v57, v32, s69, v57
    v_dot2_f32_bf16 v58, v33, s68, v58
    v_dot2_f32_bf16 v59, v33, s69, v59
    v_dot2_f32_bf16 v60, v34, s68, v60
    v_dot2_f32_bf16 v61, v34, s69, v61
    v_dot2_f32_bf16 v62, v35, s68, v62
    v_dot2_f32_bf16 v63, v35, s69, v63
    s_mov_b64 exec, 1
    ds_add_u32 v159, v163 offset:104
    s_mov_b64 exec, -1
    v_pk_mul_f32 v[56:57], v[56:57], v[36:37] op_sel_hi:[1,0]
    v_pk_mul_f32 v[58:59], v[58:59], v[36:37] op_sel_hi:[1,0]
    v_pk_mul_f32 v[60:61], v[60:61], v[36:37] op_sel_hi:[1,0]
    v_pk_mul_f32 v[62:63], v[62:63], v[36:37] op_sel_hi:[1,0]
    v_cvt_pk_bf16_f32 v24, v56, v57
    v_cvt_pk_bf16_f32 v25, v58, v59
    v_cvt_pk_bf16_f32 v26, v60, v61
    v_cvt_pk_bf16_f32 v27, v62, v63
    v_min_u32 v24, -2, v24
    v_min_u32 v25, -2, v25
    v_min_u32 v26, v153, v26
    v_min_u32 v27, v153, v27
    v_readfirstlane_b32 s70, v19
    s_nop 1
    s_cmp_lg_u32 s70, 0
    s_cbranch_scc1 L_OSTP
    buffer_store_dwordx4 v[24:27], v1, s[44:47], s12 offen sc1
    s_branch L_OSTD
L_OSTP:
    buffer_store_dwordx4 v[24:27], v1, s[44:47], s12 offen
L_OSTD:
    s_mov_b32 s48, s38
    s_mov_b32 s49, s39
    s_mov_b32 s50, 3670016
    s_mov_b32 s51, 0x20000
    s_cmp_lt_u32 s3, 4
    s_cbranch_scc1 L_AFINAL
    s_setprio 2
    s_cmp_eq_u32 s5, 1
    s_cbranch_scc1 L_AF_SKIP
    s_waitcnt vmcnt(0)
    s_setprio 3
    buffer_load_dwordx4 v[88:91], v1, s[44:47], s100 offen offset:0 sc1
    buffer_load_dwordx4 v[92:95], v1, s[44:47], s100 offen offset:1024 sc1
    buffer_load_dwordx4 v[96:99], v1, s[44:47], s100 offen offset:2048 sc1
    buffer_load_dwordx4 v[100:103], v1, s[44:47], s100 offen offset:3072 sc1
    s_setprio 2
    buffer_load_dwordx4 v[104:107], v1, s[44:47], s101 offen offset:0 sc1
    buffer_load_dwordx4 v[108:111], v1, s[44:47], s101 offen offset:1024 sc1
    buffer_load_dwordx4 v[112:115], v1, s[44:47], s101 offen offset:2048 sc1
    buffer_load_dwordx4 v[116:119], v1, s[44:47], s101 offen offset:3072 sc1
    v_readfirstlane_b32 s70, v158
    s_cmp_lt_u32 s70, 4
    s_cbranch_scc1 L_WDX
L_WDY:
    ds_read_b64_tr_b16 v[24:25], v164 offset:0
    ds_read_b64_tr_b16 v[26:27], v164 offset:1024
    ds_read_b64_tr_b16 v[28:29], v154 offset:0
    ds_read_b64_tr_b16 v[30:31], v154 offset:1024
    ds_read_b64_tr_b16 v[32:33], v164 offset:2048
    ds_read_b64_tr_b16 v[34:35], v164 offset:3072
    ds_read_b64_tr_b16 v[36:37], v154 offset:2048
    ds_read_b64_tr_b16 v[38:39], v154 offset:3072
    ds_read_b64_tr_b16 v[40:41], v164 offset:3584
    ds_read_b64_tr_b16 v[42:43], v164 offset:4608
    ds_read_b64_tr_b16 v[44:45], v154 offset:3584
    ds_read_b64_tr_b16 v[46:47], v154 offset:4608
    s_waitcnt vmcnt(4)
    v_max3_u32 v8, v88, v89, v90
    v_max3_u32 v9, v91, v92, v93
    v_max3_u32 v8, v8, v94, v95
    v_max3_u32 v9, v9, v96, v97
    v_max3_u32 v8, v8, v98, v99
    v_max3_u32 v9, v9, v100, v101
    v_max3_u32 v8, v8, v102, v103
    v_max_u32 v8, v8, v9
    v_cmp_eq_u32 vcc, -1, v8
    s_nop 1
    s_cbranch_vccnz L_OR_31
L_OK_30:
    s_waitcnt lgkmcnt(8)
    v_mfma_f32_32x32x16_bf16 v[56:71], v[24:27], v[88:91], 0
    buffer_load_dwordx4 v[120:123], v1, s[44:47], s14 offen offset:0 sc1
    buffer_load_dwordx4 v[124:127], v1, s[44:47], s14 offen offset:1024 sc1
    ds_read_b64_tr_b16 v[48:49], v164 offset:5632
    ds_read_b64_tr_b16 v[50:51], v164 offset:6656
    ds_read_b64_tr_b16 v[52:53], v154 offset:5632
    ds_read_b64_tr_b16 v[54:55], v154 offset:6656
    v_mfma_f32_32x32x16_bf16 v[72:87], v[28:31], v[88:91], 0
    s_waitcnt lgkmcnt(8)
    v_mfma_f32_32x32x16_bf16 v[56:71], v[32:35], v[92:95], v[56:71]
    buffer_load_dwordx4 v[128:131], v1, s[44:47], s14 offen offset:2048 sc1
    buffer_load_dwordx4 v[132:135], v1, s[44:47], s14 offen offset:3072 sc1
    ds_read_b64_tr_b16 v[24:25], v165 offset:0
    ds_read_b64_tr_b16 v[26:27], v165 offset:1024
    ds_read_b64_tr_b16 v[28:29], v155 offset:0
    ds_read_b64_tr_b16 v[30:31], v155 offset:1024
    v_mfma_f32_32x32x16_bf16 v[72:87], v[36:39], v[92:95], v[72:87]
    s_waitcnt lgkmcnt(8)
    v_mfma_f32_32x32x16_bf16 v[56:71], v[40:43], v[96:99], v[56:71]
    ds_read_b64_tr_b16 v[32:33], v165 offset:2048
    ds_read_b64_tr_b16 v[34:35], v165 offset:3072
    ds_read_b64_tr_b16 v[36:37], v155 offset:2048
    ds_read_b64_tr_b16 v[38:39], v155 offset:3072
    v_mfma_f32_32x32x16_bf16 v[72:87], v[44:47], v[96:99], v[72:87]
    s_waitcnt vmcnt(4)
    v_max3_u32 v8, v104, v105, v106
    v_max3_u32 v9, v107, v108, v109
    v_max3_u32 v8, v8, v110, v111
    v_max3_u32 v9, v9, v112, v113
    v_max3_u32 v8, v8, v114, v115
    v_max3_u32 v9, v9, v116, v117
    v_max3_u32 v8, v8, v118, v119
    v_max_u32 v8, v8, v9
    v_cmp_eq_u32 vcc, -1, v8
    s_waitcnt lgkmcnt(8)
    v_mfma_f32_32x32x16_bf16 v[56:71], v[48:51], v[100:103], v[56:71]
    ds_read_b64_tr_b16 v[40:41], v165 offset:3584
    ds_read_b64_tr_b16 v[42:43], v165 offset:4608
    ds_read_b64_tr_b16 v[44:45], v155 offset:3584
    ds_read_b64_tr_b16 v[46:47], v155 offset:4608
    v_mfma_f32_32x32x16_bf16 v[72:87], v[52:55], v[100:103], v[72:87]
    s_cbranch_vccnz L_OR_34
L_OK_33:
    s_waitcnt lgkmcnt(8)
    v_mfma_f32_32x32x16_bf16 v[56:71], v[24:27], v[104:107], v[56:71]
    buffer_load_dwordx4 v[136:139], v1, s[44:47], s15 offen offset:0 sc1
    buffer_load_dwordx4 v[140:143], v1, s[44:47], s15 offen offset:1024 sc1
    ds_read_b64_tr_b16 v[48:49], v165 offset:5632
    ds_read_b64_tr_b16 v[50:51], v165 offset:6656
    ds_read_b64_tr_b16 v[52:53], v155 offset:5632
    ds_read_b64_tr_b16 v[54:55], v155 offset:6656
    v_mfma_f32_32x32x16_bf16 v[72:87], v[28:31], v[104:107], v[72:87]
    s_waitcnt lgkmcnt(8)
    v_mfma_f32_32x32x16_bf16 v[56:71], v[32:35], v[108:111], v[56:71]
    buffer_load_dwordx4 v[144:147], v1, s[44:47], s15 offen offset:2048 sc1
    buffer_load_dwordx4 v[148:151], v1, s[44:47], s15 offen offset:3072 sc1
    ds_read_b64_tr_b16 v[24:25], v166 offset:0
    ds_read_b64_tr_b16 v[26:27], v166 offset:1024
    ds_read_b64_tr_b16 v[28:29], v156 offset:0
    ds_read_b64_tr_b16 v[30:31], v156 offset:1024
    v_mfma_f32_32x32x16_bf16 v[72:87], v[36:39], v[108:111], v[72:87]
    s_waitcnt lgkmcnt(8)
    v_mfma_f32_32x32x16_bf16 v[56:71], v[40:43], v[112:115], v[56:71]
    ds_read_b64_tr_b16 v[32:33], v166 offset:2048
    ds_read_b64_tr_b16 v[34:35], v166 offset:3072
    ds_read_b64_tr_b16 v[36:37], v156 offset:2048
    ds_read_b64_tr_b16 v[38:39], v156 offset:3072
    v_mfma_f32_32x32x16_bf16 v[72:87], v[44:47], v[112:115], v[72:87]
    s_waitcnt vmcnt(4)
    v_max3_u32 v8, v120, v121, v122
    v_max3_u32 v9, v123, v124, v125
    v_max3_u32 v8, v8, v126, v127
    v_max3_u32 v9, v9, v128, v129
    v_max3_u32 v8, v8, v130, v131
    v_max3_u32 v9, v9, v132, v133
    v_max3_u32 v8, v8, v134, v135
    v_max_u32 v8, v8, v9
    v_cmp_eq_u32 vcc, -1, v8
    s_waitcnt lgkmcnt(8)
    v_mfma_f32_32x32x16_bf16 v[56:71], v[48:51], v[116:119], v[56:71]
    ds_read_b64_tr_b16 v[40:41], v166 offset:3584
    ds_read_b64_tr_b16 v[42:43], v166 offset:4608
    ds_read_b64_tr_b16 v[44:45], v156 offset:3584
    ds_read_b64_tr_b16 v[46:47], v156 offset:4608
    v_mfma_f32_32x32x16_bf16 v[72:87], v[52:55], v[116:119], v[72:87]
    s_cbranch_vccnz L_OR_37
L_OK_36:
    s_waitcnt lgkmcnt(8)
    v_mfma_f32_32x32x16_bf16 v[56:71], v[24:27], v[120:123], v[56:71]
    ds_read_b64_tr_b16 v[48:49], v166 offset:5632
    ds_read_b64_tr_b16 v[50:51], v166 offset:6656
    ds_read_b64_tr_b16 v[52:53], v156 offset:5632
    ds_read_b64_tr_b16 v[54:55], v156 offset:6656
    v_mfma_f32_32x32x16_bf16 v[72:87], v[28:31], v[120:123], v[72:87]
    s_waitcnt lgkmcnt(8)
    v_mfma_f32_32x32x16_bf16 v[56:71], v[32:35], v[124:127], v[56:71]
    ds_read_b64_tr_b16 v[24:25], v167 offset:0
    ds_read_b64_tr_b16 v[26:27], v167 offset:1024
    ds_read_b64_tr_b16 v[28:29], v157 offset:0
    ds_read_b64_tr_b16 v[30:31], v157 offset:1024
    v_mfma_f32_32x32x16_bf16 v[72:87], v[36:39], v[124:127], v[72:87]
    s_waitcnt lgkmcnt(8)
    v_mfma_f32_32x32x16_bf16 v[56:71], v[40:43], v[128:131], v[56:71]
    ds_read_b64_tr_b16 v[32:33], v167 offset:2048
    ds_read_b64_tr_b16 v[34:35], v167 offset:3072
    ds_read_b64_tr_b16 v[36:37], v157 offset:2048
    ds_read_b64_tr_b16 v[38:39], v157 offset:3072
    v_mfma_f32_32x32x16_bf16 v[72:87], v[44:47], v[128:131], v[72:87]
    s_waitcnt vmcnt(0)
    v_max3_u32 v8, v136, v137, v138
    v_max3_u32 v9, v139, v140, v141
    v_max3_u32 v8, v8, v142, v143
    v_max3_u32 v9, v9, v144, v145
    v_max3_u32 v8, v8, v146, v147
    v_max3_u32 v9, v9, v148, v149
    v_max3_u32 v8, v8, v150, v151
    v_max_u32 v8, v8, v9
    v_cmp_eq_u32 vcc, -1, v8
    s_waitcnt lgkmcnt(8)
    v_mfma_f32_32x32x16_bf16 v[56:71], v[48:51], v[132:135], v[56:71]
    ds_read_b64_tr_b16 v[40:41], v167 offset:3584
    ds_read_b64_tr_b16 v[42:43], v167 offset:4608
    ds_read_b64_tr_b16 v[44:45], v157 offset:3584
    ds_read_b64_tr_b16 v[46:47], v157 offset:4608
    v_mfma_f32_32x32x16_bf16 v[72:87], v[52:55], v[132:135], v[72:87]
    s_cbranch_vccnz L_OR_40
L_OK_39:
    s_waitcnt lgkmcnt(8)
    v_mfma_f32_32x32x16_bf16 v[72:87], v[28:31], v[136:139], v[72:87]
    ds_read_b64_tr_b16 v[48:49], v167 offset:5632
    ds_read_b64_tr_b16 v[50:51], v167 offset:6656
    ds_read_b64_tr_b16 v[52:53], v157 offset:5632
    ds_read_b64_tr_b16 v[54:55], v157 offset:6656
    ds_read_b32 v17, v159 offset:104
    s_waitcnt lgkmcnt(9)
    v_mfma_f32_32x32x16_bf16 v[72:87], v[36:39], v[140:143], v[72:87]
    s_waitcnt lgkmcnt(5)
    v_mfma_f32_32x32x16_bf16 v[72:87], v[44:47], v[144:147], v[72:87]
    s_waitcnt lgkmcnt(0)
    v_mfma_f32_32x32x16_bf16 v[72:87], v[52:55], v[148:151], v[72:87]
    v_mfma_f32_32x32x16_bf16 v[56:71], v[24:27], v[136:139], v[56:71]
    v_readfirstlane_b32 s70, v17
    s_cmp_lt_u32 s70, 8
    s_cbranch_scc1 L_ORX
L_ORY:
    v_mfma_f32_32x32x16_bf16 v[56:71], v[32:35], v[140:143], v[56:71]
    s_nop 3
    v_mfma_f32_32x32x16_bf16 v[56:71], v[40:43], v[144:147], v[56:71]
    s_nop 1
    ds_write_b128 v13, v[72:75]
    ds_write_b128 v13, v[76:79] offset:1024
    v_mfma_f32_32x32x16_bf16 v[56:71], v[48:51], v[148:151], v[56:71]
    ds_write_b128 v13, v[80:83] offset:2048
    ds_write_b128 v13, v[84:87] offset:3072
    s_mov_b64 exec, 1
    ds_add_u32 v12, v163 offset:112
    s_mov_b64 exec, -1
    s_mov_b32 s71, 960000
L_LW_41:
    ds_read_b32 v17, v11 offset:112
    s_waitcnt lgkmcnt(0)
    v_readfirstlane_b32 s70, v17
    s_sub_u32 s71, s71, 1
    s_cbranch_scc1 L_LK_42
    s_cmp_lt_u32 s70, 1
    s_cbranch_scc1 L_LW_41
L_LK_42:
    ds_read_b128 v[24:27], v14 offset:0
    ds_read_b128 v[28:31], v14 offset:1024
    ds_read_b128 v[32:35], v14 offset:2048
    ds_read_b128 v[36:39], v14 offset:3072
    s_waitcnt lgkmcnt(3)
    v_pk_add_f32 v[56:57], v[56:57], v[24:25]
    v_pk_add_f32 v[58:59], v[58:59], v[26:27]
    v_cvt_pk_bf16_f32 v40, v56, v57
    v_cvt_pk_bf16_f32 v41, v58, v59
    s_waitcnt lgkmcnt(2)
    v_pk_add_f32 v[60:61], v[60:61], v[28:29]
    v_pk_add_f32 v[62:63], v[62:63], v[30:31]
    v_cvt_pk_bf16_f32 v42, v60, v61
    v_cvt_pk_bf16_f32 v43, v62, v63
    s_nop 1
    v_permlane32_swap_b32 v40, v42
    v_permlane32_swap_b32 v41, v43
    s_waitcnt lgkmcnt(1)
    v_pk_add_f32 v[64:65], v[64:65], v[32:33]
    v_pk_add_f32 v[66:67], v[66:67], v[34:35]
    v_cvt_pk_bf16_f32 v44, v64, v65
    v_cvt_pk_bf16_f32 v45, v66, v67
    s_waitcnt lgkmcnt(0)
    v_pk_add_f32 v[68:69], v[68:69], v[36:37]
    v_pk_add_f32 v[70:71], v[70:71], v[38:39]
    v_cvt_pk_bf16_f32 v46, v68, v69
    v_cvt_pk_bf16_f32 v47, v70, v71
    s_nop 1
    v_permlane32_swap_b32 v44, v46
    v_permlane32_swap_b32 v45, v47
    s_cmp_eq_u32 s66, s66
    s_cselect_b32 s70, -1, 0xffff
    v_permlane16_swap_b32 v40, v44
    v_permlane16_swap_b32 v41, v45
    v_permlane16_swap_b32 v42, v46
    v_permlane16_swap_b32 v43, v47
    s_mov_b32 exec_hi, s70
    s_add_u32 s70, s65, 28672
    buffer_store_dwordx4 v[40:43], v15, s[48:51], s65 offen
    buffer_store_dwordx4 v[44:47], v15, s[48:51], s70 offen
    s_endpgm
L_OR_31:
    s_mov_b32 s71, 60000
L_OP_29:
    buffer_load_dwordx4 v[88:91], v1, s[44:47], s100 offen offset:0 sc1
    buffer_load_dwordx4 v[92:95], v1, s[44:47], s100 offen offset:1024 sc1
    buffer_load_dwordx4 v[96:99], v1, s[44:47], s100 offen offset:2048 sc1
    buffer_load_dwordx4 v[100:103], v1, s[44:47], s100 offen offset:3072 sc1
    s_waitcnt vmcnt(0)
    v_max3_u32 v8, v88, v89, v90
    v_max3_u32 v9, v91, v92, v93
    v_max3_u32 v8, v8, v94, v95
    v_max3_u32 v9, v9, v96, v97
    v_max3_u32 v8, v8, v98, v99
    v_max3_u32 v9, v9, v100, v101
    v_max3_u32 v8, v8, v102, v103
    v_max_u32 v8, v8, v9
    v_cmp_eq_u32 vcc, -1, v8
    s_sub_u32 s71, s71, 1
    s_cbranch_scc1 L_OK_30
    s_nop 0
    s_cbranch_vccnz L_OP_29
    s_branch L_OK_30
L_OR_34:
    s_mov_b32 s71, 60000
L_OP_32:
    buffer_load_dwordx4 v[104:107], v1, s[44:47], s101 offen offset:0 sc1
    buffer_load_dwordx4 v[108:111], v1, s[44:47], s101 offen offset:1024 sc1
    buffer_load_dwordx4 v[112:115], v1, s[44:47], s101 offen offset:2048 sc1
    buffer_load_dwordx4 v[116:119], v1, s[44:47], s101 offen offset:3072 sc1
    s_waitcnt vmcnt(0)
    v_max3_u32 v8, v104, v105, v106
    v_max3_u32 v9, v107, v108, v109
    v_max3_u32 v8, v8, v110, v111
    v_max3_u32 v9, v9, v112, v113
    v_max3_u32 v8, v8, v114, v115
    v_max3_u32 v9, v9, v116, v117
    v_max3_u32 v8, v8, v118, v119
    v_max_u32 v8, v8, v9
    v_cmp_eq_u32 vcc, -1, v8
    s_sub_u32 s71, s71, 1
    s_cbranch_scc1 L_OK_33
    s_nop 0
    s_cbranch_vccnz L_OP_32
    s_branch L_OK_33
L_OR_37:
    s_mov_b32 s71, 60000
L_OP_35:
    buffer_load_dwordx4 v[120:123], v1, s[44:47], s14 offen offset:0 sc1
    buffer_load_dwordx4 v[124:127], v1, s[44:47], s14 offen offset:1024 sc1
    buffer_load_dwordx4 v[128:131], v1, s[44:47], s14 offen offset:2048 sc1
    buffer_load_dwordx4 v[132:135], v1, s[44:47], s14 offen offset:3072 sc1
    s_waitcnt vmcnt(0)
    v_max3_u32 v8, v120, v121, v122
    v_max3_u32 v9, v123, v124, v125
    v_max3_u32 v8, v8, v126, v127
    v_max3_u32 v9, v9, v128, v129
    v_max3_u32 v8, v8, v130, v131
    v_max3_u32 v9, v9, v132, v133
    v_max3_u32 v8, v8, v134, v135
    v_max_u32 v8, v8, v9
    v_cmp_eq_u32 vcc, -1, v8
    s_sub_u32 s71, s71, 1
    s_cbranch_scc1 L_OK_36
    s_nop 0
    s_cbranch_vccnz L_OP_35
    s_branch L_OK_36
L_OR_40:
    s_mov_b32 s71, 60000
L_OP_38:
    buffer_load_dwordx4 v[136:139], v1, s[44:47], s15 offen offset:0 sc1
    buffer_load_dwordx4 v[140:143], v1, s[44:47], s15 offen offset:1024 sc1
    buffer_load_dwordx4 v[144:147], v1, s[44:47], s15 offen offset:2048 sc1
    buffer_load_dwordx4 v[148:151], v1, s[44:47], s15 offen offset:3072 sc1
    s_waitcnt vmcnt(0)
    v_max3_u32 v8, v136, v137, v138
    v_max3_u32 v9, v139, v140, v141
    v_max3_u32 v8, v8, v142, v143
    v_max3_u32 v9, v9, v144, v145
    v_max3_u32 v8, v8, v146, v147
    v_max3_u32 v9, v9, v148, v149
    v_max3_u32 v8, v8, v150, v151
    v_max_u32 v8, v8, v9
    v_cmp_eq_u32 vcc, -1, v8
    s_sub_u32 s71, s71, 1
    s_cbranch_scc1 L_OK_39
    s_nop 0
    s_cbranch_vccnz L_OP_38
    s_branch L_OK_39
L_WDX:
    s_mov_b32 s71, 960000
L_LW_43:
    ds_read_b32 v17, v159 offset:92
    s_waitcnt lgkmcnt(0)
    v_readfirstlane_b32 s70, v17
    s_sub_u32 s71, s71, 1
    s_cbranch_scc1 L_LK_44
    s_cmp_lt_u32 s70, 4
    s_cbranch_scc1 L_LW_43
L_LK_44:
    s_branch L_WDY
L_ORX:
    s_mov_b32 s71, 960000
L_LW_45:
    ds_read_b32 v17, v159 offset:104
    s_waitcnt lgkmcnt(0)
    v_readfirstlane_b32 s70, v17
    s_sub_u32 s71, s71, 1
    s_cbranch_scc1 L_LK_46
    s_cmp_lt_u32 s70, 8
    s_cbranch_scc1 L_LW_45
L_LK_46:
    s_branch L_ORY
L_AFINAL:
    s_setprio 0
    s_cmp_eq_u32 s5, 7
    s_cbranch_scc1 L_AF_SKIP
    s_mov_b32 s71, 60000
    s_waitcnt vmcnt(1)
L_YP:
    v_max3_u32 v17, v112, v113, v114
    v_max3_u32 v18, v115, v116, v117
    v_max3_u32 v17, v17, v118, v119
    v_max_u32 v17, v17, v18
    v_cmp_eq_u32 vcc, -1, v17
    s_sub_u32 s71, s71, 1
    s_cbranch_scc1 L_YHAVE
    s_nop 0
    s_cbranch_vccz L_YHAVE
    s_sleep 4
    buffer_load_dwordx4 v[112:115], v12, s[44:47], s65 offen sc1
    buffer_load_dwordx4 v[116:119], v12, s[44:47], s98 offen sc1
    s_waitcnt vmcnt(0)
    s_branch L_YP
L_YHAVE:
    ds_read2_b32 v[40:41], v11 offset0:0 offset1:32
    ds_read2_b32 v[42:43], v11 offset0:64 offset1:96
    ds_read2_b32 v[44:45], v11 offset0:128 offset1:160
    ds_read2_b32 v[46:47], v11 offset0:192 offset1:224
    s_add_u32 s15, s67, 14336
    v_xor_b32 v7, 16, v15
    s_lshl_b32 s70, s3, 11
    s_add_u32 s70, s70, 48640
    v_add_u32 v8, s70, v1
    s_mov_b32 s69, 0xffff0000
    s_waitcnt vmcnt(1) lgkmcnt(0)
    v_lshlrev_b32 v22, 16, v20
    v_and_b32 v23, s69, v20
    v_lshlrev_b32 v48, 16, v112
    v_lshlrev_b32 v49, 16, v116
    v_and_b32 v50, s69, v107
    v_and_b32 v51, s69, v111
    v_lshlrev_b32 v52, 16, v40
    v_and_b32 v53, s69, v40
    v_pk_fma_f32 v[48:49], v[50:51], v[22:23], v[48:49]
    v_pk_mul_f32 v[48:49], v[48:49], v[52:53]
    v_cvt_pk_bf16_f32 v60, v48, v49
    v_and_b32 v54, s69, v112
    v_and_b32 v55, s69, v116
    v_lshlrev_b32 v56, 16, v107
    v_lshlrev_b32 v57, 16, v111
    v_lshlrev_b32 v58, 16, v41
    v_and_b32 v59, s69, v41
    v_pk_fma_f32 v[54:55], v[56:57], v[22:23], v[54:55]
    v_pk_mul_f32 v[54:55], v[54:55], v[58:59]
    v_cvt_pk_bf16_f32 v61, v54, v55
    ds_write2_b32 v11, v60, v61 offset0:0 offset1:32
    v_lshlrev_b32 v48, 16, v113
    v_lshlrev_b32 v49, 16, v117
    v_and_b32 v50, s69, v106
    v_and_b32 v51, s69, v110
    v_lshlrev_b32 v52, 16, v42
    v_and_b32 v53, s69, v42
    v_pk_fma_f32 v[48:49], v[50:51], v[22:23], v[48:49]
    v_pk_mul_f32 v[48:49], v[48:49], v[52:53]
    v_cvt_pk_bf16_f32 v62, v48, v49
    v_and_b32 v54, s69, v113
    v_and_b32 v55, s69, v117
    v_lshlrev_b32 v56, 16, v106
    v_lshlrev_b32 v57, 16, v110
    v_lshlrev_b32 v58, 16, v43
    v_and_b32 v59, s69, v43
    v_pk_fma_f32 v[54:55], v[56:57], v[22:23], v[54:55]
    v_pk_mul_f32 v[54:55], v[54:55], v[58:59]
    v_cvt_pk_bf16_f32 v63, v54, v55
    ds_write2_b32 v11, v62, v63 offset0:64 offset1:96
    v_lshlrev_b32 v48, 16, v114
    v_lshlrev_b32 v49, 16, v118
    v_and_b32 v50, s69, v105
    v_and_b32 v51, s69, v109
    v_lshlrev_b32 v52, 16, v44
    v_and_b32 v53, s69, v44
    v_pk_fma_f32 v[48:49], v[50:51], v[22:23], v[48:49]
    v_pk_mul_f32 v[48:49], v[48:49], v[52:53]
    v_cvt_pk_bf16_f32 v64, v48, v49
    v_and_b32 v54, s69, v114
    v_and_b32 v55, s69, v118
    v_lshlrev_b32 v56, 16, v105
    v_lshlrev_b32 v57, 16, v109
    v_lshlrev_b32 v58, 16, v45
    v_and_b32 v59, s69, v45
    v_pk_fma_f32 v[54:55], v[56:57], v[22:23], v[54:55]
    v_pk_mul_f32 v[54:55], v[54:55], v[58:59]
    v_cvt_pk_bf16_f32 v65, v54, v55
    ds_write2_b32 v11, v64, v65 offset0:128 offset1:160
    v_lshlrev_b32 v48, 16, v115
    v_lshlrev_b32 v49, 16, v119
    v_and_b32 v50, s69, v104
    v_and_b32 v51, s69, v108
    v_lshlrev_b32 v52, 16, v46
    v_and_b32 v53, s69, v46
    v_pk_fma_f32 v[48:49], v[50:51], v[22:23], v[48:49]
    v_pk_mul_f32 v[48:49], v[48:49], v[52:53]
    v_cvt_pk_bf16_f32 v66, v48, v49
    v_and_b32 v54, s69, v115
    v_and_b32 v55, s69, v119
    v_lshlrev_b32 v56, 16, v104
    v_lshlrev_b32 v57, 16, v108
    v_lshlrev_b32 v58, 16, v47
    v_and_b32 v59, s69, v47
    v_pk_fma_f32 v[54:55], v[56:57], v[22:23], v[54:55]
    v_pk_mul_f32 v[54:55], v[54:55], v[58:59]
    v_cvt_pk_bf16_f32 v67, v54, v55
    ds_write2_b32 v11, v66, v67 offset0:192 offset1:224
    s_mov_b64 exec, 1
    ds_add_u32 v159, v163 offset:108
    s_mov_b64 exec, -1
    s_mov_b32 s71, 960000
L_LW_47:
    ds_read_b32 v17, v159 offset:108
    s_waitcnt lgkmcnt(0)
    v_readfirstlane_b32 s70, v17
    s_sub_u32 s71, s71, 1
    s_cbranch_scc1 L_LK_48
    s_cmp_lt_u32 s70, 4
    s_cbranch_scc1 L_LW_47
L_LK_48:
    ds_read_b128 v[24:27], v8
    ds_read_b128 v[28:31], v8 offset:1024
    s_waitcnt lgkmcnt(1)
    buffer_store_dwordx4 v[24:27], v15, s[48:51], s67 offen
    s_waitcnt lgkmcnt(0)
    buffer_store_dwordx4 v[28:31], v7, s[48:51], s15 offen
L_AF_SKIP:
    s_endpgm
L_SLOW:
    s_waitcnt vmcnt(0)
    s_mov_b32 s68, 262144
    s_mov_b32 s69, 64
    v_mov_b32 v151, 0
    v_mov_b32 v16, 0xff800000
    v_mov_b32 v17, 0xff800000
L_SLOWLP:
    buffer_load_dwordx4 v[144:147], v1, s[44:47], s68 offen
    buffer_load_dwordx3 v[148:150], v152, s[44:47], s68 offen offset:1024
    s_waitcnt vmcnt(0)
    v_mfma_f32_32x32x16_bf16 v[24:39], v[144:147], v[88:91], 0
    v_mfma_f32_32x32x16_bf16 v[24:39], v[148:151], v[92:95], v[24:39]
    v_mfma_f32_32x32x16_bf16 v[40:55], v[144:147], v[96:99], 0
    v_mfma_f32_32x32x16_bf16 v[40:55], v[148:151], v[100:103], v[40:55]
    s_nop 7
    s_nop 3
    v_max3_f32 v16, v16, v24, v25
    v_max3_f32 v16, v16, v26, v27
    v_max3_f32 v16, v16, v28, v29
    v_max3_f32 v16, v16, v30, v31
    v_max3_f32 v16, v16, v32, v33
    v_max3_f32 v16, v16, v34, v35
    v_max3_f32 v16, v16, v36, v37
    v_max3_f32 v16, v16, v38, v39
    v_max3_f32 v17, v17, v40, v41
    v_max3_f32 v17, v17, v42, v43
    v_max3_f32 v17, v17, v44, v45
    v_max3_f32 v17, v17, v46, v47
    v_max3_f32 v17, v17, v48, v49
    v_max3_f32 v17, v17, v50, v51
    v_max3_f32 v17, v17, v52, v53
    v_max3_f32 v17, v17, v54, v55
    s_add_u32 s68, s68, 4096
    s_sub_u32 s69, s69, 1
    s_cmp_lg_u32 s69, 0
    s_cbranch_scc1 L_SLOWLP
    v_mov_b32 v18, v16
    s_nop 1
    v_permlane32_swap_b32 v16, v18
    s_nop 1
    v_max_f32 v16, v16, v18
    v_mov_b32 v18, v17
    s_nop 1
    v_permlane32_swap_b32 v17, v18
    s_nop 1
    v_max_f32 v17, v17, v18
    s_mov_b32 s69, 0xffff0000
    v_sub_f32 v16, 0, v16
    v_and_b32 v18, s69, v16
    v_sub_f32 v16, v16, v18
    v_and_b32 v19, s69, v16
    v_sub_f32 v16, v16, v19
    v_lshrrev_b32 v18, 16, v18
    v_or_b32 v95, v18, v19
    s_mov_b32 exec_lo, 0
    s_mov_b32 exec_hi, -1
    v_lshrrev_b32 v95, 16, v16
    s_mov_b64 exec, -1
    v_sub_f32 v17, 0, v17
    v_and_b32 v18, s69, v17
    v_sub_f32 v17, v17, v18
    v_and_b32 v19, s69, v17
    v_sub_f32 v17, v17, v19
    v_lshrrev_b32 v18, 16, v18
    v_or_b32 v103, v18, v19
    s_mov_b32 exec_lo, 0
    s_mov_b32 exec_hi, -1
    v_lshrrev_b32 v103, 16, v17
    s_mov_b64 exec, -1
    s_mov_b64 exec, -1
    s_nop 1
    s_branch L_ATT
L_WDW:
    s_mov_b32 s71, 960000
L_LW_49:
    ds_read_b32 v158, v159 offset:128
    s_waitcnt lgkmcnt(0)
    v_readfirstlane_b32 s70, v158
    s_sub_u32 s71, s71, 1
    s_cbranch_scc1 L_LK_50
    s_cmp_lt_u32 s70, 4
    s_cbranch_scc1 L_LW_49
L_LK_50:
    s_branch L_WDB
L_AUX:
    s_sub_u32 s8, s3, 8
    s_lshr_b32 s9, s8, 1
    s_and_b32 s10, s8, 1
    s_lshl_b32 s11, s5, 6
    s_lshl_b32 s13, s8, 4
    s_add_u32 s11, s11, s13
    s_sub_u32 s12, s2, 32
    s_lshl_b32 s12, s12, 1
    s_add_u32 s12, s12, s9
    v_lshrrev_b32 v4, 3, v0
    v_and_b32 v5, 7, v0
    v_mul_u32_u24 v6, 896, v4
    v_lshl_add_u32 v6, v5, 4, v6
    s_mul_i32 s13, s4, 57344
    s_lshl_b32 s14, s5, 7
    s_add_u32 s13, s13, s14
    s_sub_u32 s14, s13, 7168
    v_add_u32 v7, s14, v6
    s_mul_i32 s14, s8, 14336
    s_add_u32 s77, s13, s14
    s_lshl_b32 s14, s8, 5
    v_xor_b32 v56, s14, v6
    v_xor_b32 v57, 16, v56
    s_add_u32 s14, s14, 32
    s_and_b32 s14, s14, 0x70
    v_xor_b32 v58, s14, v6
    v_lshlrev_b32 v8, 4, v4
    v_lshlrev_b32 v9, 13, v4
    v_lshlrev_b32 v10, 4, v5
    v_sub_u32 v9, v9, v10
    v_add_u32 v9, 112, v9
    s_lshl_b32 s14, s8, 1
    v_lshrrev_b32 v59, 5, v0
    v_add_u32 v59, s14, v59
    v_and_b32 v60, 3, v4
    v_lshlrev_b32 v60, 2, v60
    v_lshl_add_u32 v60, v5, 10, v60
    v_xor_b32 v61, v59, v5
    v_lshl_add_u32 v61, v61, 4, v60
    v_add_u32 v62, 1, v5
    v_and_b32 v62, 7, v62
    v_xor_b32 v62, v59, v62
    v_lshl_add_u32 v62, v62, 4, v60
    v_add_u32 v62, 144384, v62
    v_add_u32 v63, 152576, v61
    v_add_u32 v61, 144000, v61
    s_lshl_b32 s13, s10, 10
    v_add_u32 v10, s13, v1
    v_subrev_u32 v11, 64, v10
    v_subrev_u32 v12, 48, v10
    v_lshrrev_b32 v13, 3, v0
    v_lshlrev_b32 v13, 11, v13
    v_and_b32 v14, 7, v0
    v_lshl_add_u32 v13, v14, 4, v13
    s_add_u32 s13, s13, 1008
    v_add_u32 v13, s13, v13
    v_subrev_u32 v14, 64, v13
    v_subrev_u32 v15, 48, v13
    v_mov_b32 v16, 0
    v_mov_b32 v17, 0
    v_mov_b32 v18, 0
    v_mov_b32 v19, 0
    v_mov_b32 v20, 160768
    s_cmp_gt_u32 s5, 1
    s_subb_u32 s72, s5, 0
    s_lshl_b32 s72, s72, 7
    s_mul_i32 s76, s8, 100352
    s_add_u32 s76, s76, s72
    s_mul_i32 s72, s8, 14336
    v_bfe_u32 v3, v0, 4, 1
    v_lshlrev_b32 v3, 6, v3
    v_xor_b32 v3, v3, v6
    s_waitcnt lgkmcnt(0)
    s_mov_b32 s44, s42
    s_mov_b32 s45, s43
    s_mov_b32 s46, 16777216
    s_mov_b32 s47, 0x20000
    s_mov_b32 s48, s18
    s_mov_b32 s49, s19
    s_mov_b32 s50, 1835008
    s_mov_b32 s51, 0x20000
    s_mov_b32 s52, s20
    s_mov_b32 s53, s21
    s_mov_b32 s54, 1835008
    s_mov_b32 s55, 0x20000
    s_mov_b32 s56, s22
    s_mov_b32 s57, s23
    s_mov_b32 s58, 3584
    s_mov_b32 s59, 0x20000
    s_mov_b32 s60, s36
    s_mov_b32 s61, s37
    s_mov_b32 s62, 401408
    s_mov_b32 s63, 0x20000
    s_cmp_ge_u32 s2, 32
    s_cselect_b32 s13, s12, 0
    s_cselect_b32 s66, 4096, 0
    s_lshl_b32 s13, s13, 12
    s_add_u32 s64, s24, s13
    s_addc_u32 s65, s25, 0
    s_mov_b32 s67, 0x20000
    s_lshl_b32 s15, s11, 3
    s_lshl_b32 s14, s8, 11
    s_setprio 2
    s_waitcnt lgkmcnt(0)
    s_mul_i32 s6, s6, 0x9E3779B1
    s_add_u32 s6, s6, 0x7F4A7C15
    s_mul_i32 s7, s7, 0x85EBCA6B
    s_add_u32 s7, s7, 0xC2B2AE35
    s_mov_b32 s71, 960000
L_LW_51:
    ds_read_b32 v65, v21 offset:68
    s_waitcnt lgkmcnt(0)
    v_readfirstlane_b32 s70, v65
    s_sub_u32 s71, s71, 1
    s_cbranch_scc1 L_LK_52
    s_cmp_ge_u32 s70, 4
    s_cbranch_scc1 L_LK_52
    s_sleep 1
    s_branch L_LW_51
L_LK_52:
    s_cmp_eq_u32 s5, 7
    s_cbranch_scc1 L_AX_NOLD
    s_add_u32 m0, s14, 144384
    s_add_u32 s70, s77, 7168
    buffer_load_dwordx4 v57, s[48:51], s77 offen  lds
    s_add_u32 m0, s14, 145408
    s_nop 0
    buffer_load_dwordx4 v58, s[48:51], s70 offen  lds
    s_add_u32 m0, s14, 152576
    s_nop 0
    buffer_load_dwordx4 v56, s[52:55], s77 offen  lds
    s_add_u32 m0, s14, 153600
    s_nop 0
    buffer_load_dwordx4 v57, s[52:55], s70 offen  lds
    s_cmp_lg_u32 s8, 0
    s_cbranch_scc1 L_AX_NOLD
    s_mov_b32 m0, 143360
    s_mov_b32 exec_lo, 0
    s_mov_b32 exec_hi, 0xffffff00
    buffer_load_dwordx4 v7, s[48:51], 0 offen lds
    s_mov_b64 exec, -1
L_AX_NOLD:
    buffer_load_dwordx4 v[44:47], v8, s[56:59], s15 offen
    s_mov_b32 s56, s16
    s_mov_b32 s57, s17
    s_mov_b32 s58, 1835008
    s_mov_b32 s59, 0x20000
    s_mov_b32 s69, 0xffff0000
    v_mov_b32 v64, 1
    s_waitcnt vmcnt(0)
    s_mov_b64 exec, 1
    ds_add_u32 v21, v64 offset:48
    s_mov_b64 exec, -1
    s_mov_b32 s71, 960000
L_LW_53:
    ds_read_b32 v65, v21 offset:48
    s_waitcnt lgkmcnt(0)
    v_readfirstlane_b32 s70, v65
    s_sub_u32 s71, s71, 1
    s_cbranch_scc1 L_LK_54
    s_cmp_lt_u32 s70, 4
    s_cbranch_scc1 L_LW_53
L_LK_54:
    s_cmp_eq_u32 s5, 7
    s_cbranch_scc1 L_AX_NOKV
    ds_read2_b32 v[24:25], v61 offset0:0 offset1:32
    ds_read_b32 v26, v61 offset:256
    ds_read2_b32 v[48:49], v62 offset0:0 offset1:32
    ds_read2_b32 v[50:51], v62 offset0:64 offset1:96
    ds_read2_b32 v[52:53], v62 offset0:128 offset1:160
    ds_read2_b32 v[54:55], v62 offset0:192 offset1:224
    ds_read2_b32 v[36:37], v63 offset0:0 offset1:32
    ds_read2_b32 v[38:39], v63 offset0:64 offset1:96
    ds_read2_b32 v[40:41], v63 offset0:128 offset1:160
    ds_read2_b32 v[42:43], v63 offset0:192 offset1:224
    s_waitcnt lgkmcnt(0)
    s_mov_b64 exec, 1
    ds_add_u32 v21, v64 offset:52
    s_mov_b64 exec, -1
    v_lshlrev_b32 v88, 16, v24
    v_and_b32 v89, s69, v24
    v_lshlrev_b32 v90, 16, v25
    v_and_b32 v91, s69, v25
    v_lshlrev_b32 v92, 16, v26
    v_and_b32 v93, s69, v26
    v_lshlrev_b32 v94, 16, v48
    v_and_b32 v95, s69, v48
    v_lshlrev_b32 v96, 16, v49
    v_and_b32 v97, s69, v49
    v_lshlrev_b32 v98, 16, v50
    v_and_b32 v99, s69, v50
    v_lshlrev_b32 v100, 16, v51
    v_and_b32 v101, s69, v51
    v_lshlrev_b32 v102, 16, v52
    v_and_b32 v103, s69, v52
    v_lshlrev_b32 v104, 16, v53
    v_and_b32 v105, s69, v53
    v_lshlrev_b32 v106, 16, v54
    v_and_b32 v107, s69, v54
    v_lshlrev_b32 v108, 16, v55
    v_and_b32 v109, s69, v55
    v_lshlrev_b32 v112, 16, v44
    v_lshlrev_b32 v113, 16, v46
    v_and_b32 v114, s69, v44
    v_and_b32 v115, s69, v46
    v_lshlrev_b32 v116, 16, v45
    v_lshlrev_b32 v117, 16, v47
    v_and_b32 v118, s69, v45
    v_and_b32 v119, s69, v47
    v_pk_mul_f32 v[120:121], v[94:95], v[112:113]
    v_pk_mul_f32 v[122:123], v[96:97], v[112:113]
    v_pk_mul_f32 v[124:125], v[98:99], v[112:113]
    v_pk_mul_f32 v[126:127], v[100:101], v[112:113]
    v_pk_mul_f32 v[128:129], v[102:103], v[112:113]
    v_pk_mul_f32 v[130:131], v[104:105], v[112:113]
    v_pk_mul_f32 v[132:133], v[106:107], v[112:113]
    v_pk_mul_f32 v[134:135], v[108:109], v[112:113]
    v_pk_fma_f32 v[120:121], v[92:93], v[114:115], v[120:121]
    v_pk_fma_f32 v[122:123], v[94:95], v[114:115], v[122:123]
    v_pk_fma_f32 v[124:125], v[96:97], v[114:115], v[124:125]
    v_pk_fma_f32 v[126:127], v[98:99], v[114:115], v[126:127]
    v_pk_fma_f32 v[128:129], v[100:101], v[114:115], v[128:129]
    v_pk_fma_f32 v[130:131], v[102:103], v[114:115], v[130:131]
    v_pk_fma_f32 v[132:133], v[104:105], v[114:115], v[132:133]
    v_pk_fma_f32 v[134:135], v[106:107], v[114:115], v[134:135]
    v_pk_fma_f32 v[120:121], v[90:91], v[116:117], v[120:121]
    v_pk_fma_f32 v[122:123], v[92:93], v[116:117], v[122:123]
    v_pk_fma_f32 v[124:125], v[94:95], v[116:117], v[124:125]
    v_pk_fma_f32 v[126:127], v[96:97], v[116:117], v[126:127]
    v_pk_fma_f32 v[128:129], v[98:99], v[116:117], v[128:129]
    v_pk_fma_f32 v[130:131], v[100:101], v[116:117], v[130:131]
    v_pk_fma_f32 v[132:133], v[102:103], v[116:117], v[132:133]
    v_pk_fma_f32 v[134:135], v[104:105], v[116:117], v[134:135]
    v_pk_fma_f32 v[120:121], v[88:89], v[118:119], v[120:121]
    v_pk_fma_f32 v[122:123], v[90:91], v[118:119], v[122:123]
    v_pk_fma_f32 v[124:125], v[92:93], v[118:119], v[124:125]
    v_pk_fma_f32 v[126:127], v[94:95], v[118:119], v[126:127]
    v_pk_fma_f32 v[128:129], v[96:97], v[118:119], v[128:129]
    v_pk_fma_f32 v[130:131], v[98:99], v[118:119], v[130:131]
    v_pk_fma_f32 v[132:133], v[100:101], v[118:119], v[132:133]
    v_pk_fma_f32 v[134:135], v[102:103], v[118:119], v[134:135]
    v_lshlrev_b32 v88, 16, v36
    v_and_b32 v89, s69, v36
    v_lshlrev_b32 v90, 16, v37
    v_and_b32 v91, s69, v37
    v_lshlrev_b32 v92, 16, v38
    v_and_b32 v93, s69, v38
    v_lshlrev_b32 v94, 16, v39
    v_and_b32 v95, s69, v39
    v_lshlrev_b32 v96, 16, v40
    v_and_b32 v97, s69, v40
    v_lshlrev_b32 v98, 16, v41
    v_and_b32 v99, s69, v41
    v_lshlrev_b32 v100, 16, v42
    v_and_b32 v101, s69, v42
    v_lshlrev_b32 v102, 16, v43
    v_and_b32 v103, s69, v43
    v_pk_mul_f32 v[120:121], v[120:121], v[88:89]
    v_pk_mul_f32 v[122:123], v[122:123], v[90:91]
    v_pk_mul_f32 v[124:125], v[124:125], v[92:93]
    v_pk_mul_f32 v[126:127], v[126:127], v[94:95]
    v_pk_mul_f32 v[128:129], v[128:129], v[96:97]
    v_pk_mul_f32 v[130:131], v[130:131], v[98:99]
    v_pk_mul_f32 v[132:133], v[132:133], v[100:101]
    v_pk_mul_f32 v[134:135], v[134:135], v[102:103]
    v_cvt_pk_bf16_f32 v24, v134, v132
    v_cvt_pk_bf16_f32 v28, v135, v133
    v_cvt_pk_bf16_f32 v25, v130, v128
    v_cvt_pk_bf16_f32 v29, v131, v129
    v_cvt_pk_bf16_f32 v26, v126, v124
    v_cvt_pk_bf16_f32 v30, v127, v125
    v_cvt_pk_bf16_f32 v27, v122, v120
    v_cvt_pk_bf16_f32 v31, v123, v121
    s_lshl_b32 s68, s11, 12
    s_lshl_b32 s70, s4, 7
    s_sub_u32 s68, s68, s70
    s_add_u32 s68, s68, 3149696
    s_add_u32 s70, s68, 4096
    buffer_store_dwordx4 v[24:27], v9, s[44:47], s68 offen sc1
    buffer_store_dwordx4 v[28:31], v9, s[44:47], s70 offen sc1
    v_lshrrev_b32 v4, 3, v0
    v_and_b32 v5, 7, v0
    v_lshlrev_b32 v4, 13, v4
    v_lshl_add_u32 v4, v5, 4, v4
    v_mov_b32 v44, -1
    v_mov_b32 v45, -1
    v_mov_b32 v46, -1
    v_mov_b32 v47, -1
    s_lshl_b32 s68, s11, 12
    s_lshl_b32 s70, s4, 7
    s_add_u32 s68, s68, s70
    s_add_u32 s68, s68, 5242880
    s_add_u32 s70, s68, 4096
    buffer_store_dwordx4 v[44:47], v4, s[44:47], s68 offen sc1
    buffer_store_dwordx4 v[44:47], v4, s[44:47], s70 offen sc1
L_AX_NOKV:
    s_mul_i32 s13, s9, 16640
    s_mul_i32 s14, s9, 7680
    s_add_u32 s14, s14, 33280
    v_lshrrev_b32 v4, 2, v0
    v_mul_u32_u24 v4, 80, v4
    v_and_b32 v5, 3, v0
    v_lshl_add_u32 v4, v5, 4, v4
    v_add_u32 v23, s14, v4
    v_add_u32 v10, s13, v10
    v_add_u32 v13, s13, v13
    v_mov_b32 v22, 1
    s_lshl_b32 s75, s5, 2
    s_add_u32 s75, s75, s8
    s_lshl_b32 s75, s75, 5
    s_add_u32 s75, s75, s4
    s_lshl_b32 s75, s75, 6
    s_lshl_b32 s68, s4, 1
    s_add_u32 s68, s68, s9
    s_lshl_b32 s68, s68, 4
    s_lshl_b32 s71, s5, 1
    s_add_u32 s68, s68, s71
    s_add_u32 s68, s68, s10
    s_lshl_b32 s68, s68, 11
    s_add_u32 s68, s68, 1048576
    v_mov_b32 v44, -1
    v_mov_b32 v45, -1
    v_mov_b32 v46, -1
    v_mov_b32 v47, -1
    s_add_u32 s70, s75, 32768
    s_waitcnt vmcnt(0)
    v_mov_b32 v24, s6
    v_mov_b32 v25, s7
    s_mov_b64 exec, 1
    buffer_store_dwordx2 v[24:25], v2, s[44:47], s70 offen sc1
    s_mov_b64 exec, -1
    s_sub_u32 s13, s2, 32
    s_lshr_b32 s15, s13, 3
    s_lshl_b32 s15, s15, 11
    s_add_u32 s15, s15, 32768
    v_and_b32 v4, 31, v0
    v_lshlrev_b32 v5, 6, v4
    s_lshl_b32 s74, s12, 12
    s_add_u32 s13, s74, 3145728
    s_mov_b32 s98, s13
    v_and_b32 v6, 3, v0
    v_mul_u32_u24 v6, 4160, v6
    v_bfe_u32 v7, v0, 2, 3
    v_lshl_add_u32 v6, v7, 3, v6
    v_lshrrev_b32 v7, 5, v0
    v_lshl_add_u32 v6, v7, 4, v6
    s_mul_i32 s13, s9, 16640
    s_lshl_b32 s70, s10, 10
    s_add_u32 s13, s13, s70
    v_add_u32 v6, s13, v6
    v_sub_u32 v8, 31, v4
    v_mul_u32_u24 v8, 80, v8
    v_lshl_add_u32 v8, v7, 4, v8
    s_mul_i32 s70, s10, 1280
    s_add_u32 s14, s14, s70
    v_add_u32 v8, s14, v8
    s_xor_b32 s70, s8, 1
    s_lshl_b32 s13, s70, 12
    s_add_u32 s13, s13, 143360
    v_add_u32 v145, s13, v1
    s_lshl_b32 s13, s8, 12
    s_add_u32 s13, s13, 143360
    v_add_u32 v146, s13, v1
    s_lshl_b32 s13, s70, 2
    s_add_u32 s13, s13, 160800
    v_mov_b32 v147, s13
    s_lshl_b32 s13, s8, 2
    s_add_u32 s13, s13, 160800
    v_mov_b32 v148, s13
    v_and_b32 v149, 15, v0
    v_lshlrev_b32 v149, 6, v149
    v_lshl_add_u32 v149, v7, 4, v149
    v_bfe_u32 v4, v0, 4, 1
    v_lshl_add_u32 v149, v4, 5, v149
    s_lshl_b32 s13, s12, 1
    s_add_u32 s13, s13, s10
    s_lshl_b32 s14, s13, 11
    s_add_u32 s14, s14, 5242880
    v_lshlrev_b32 v4, 7, v0
    v_add_u32 v151, 4160, v10
    v_add_u32 v152, 6208, v10
    v_add_u32 v153, 4160, v13
    v_add_u32 v66, 2048, v11
    s_getreg_b32 s71, hwreg(HW_REG_XCC_ID, 0, 4)
    s_xor_b32 s71, s71, s7
    v_mov_b32 v48, s6
    v_mov_b32 v49, s71
    s_cmp_eq_u32 s5, 7
    s_cbranch_scc1 L_AB2OK
    s_mov_b32 s71, 960000
L_LW_55:
    ds_read_b32 v65, v21 offset:52
    s_waitcnt lgkmcnt(0)
    v_readfirstlane_b32 s70, v65
    s_sub_u32 s71, s71, 1
    s_cbranch_scc1 L_LK_56
    s_cmp_ge_u32 s70, 4
    s_cbranch_scc1 L_LK_56
    s_sleep 1
    s_branch L_LW_55
L_LK_56:
L_AB2OK:
    s_mov_b32 s71, 960000
L_LW_57:
    ds_read_b32 v65, v21 offset:136
    s_waitcnt lgkmcnt(0)
    v_readfirstlane_b32 s70, v65
    s_sub_u32 s71, s71, 1
    s_cbranch_scc1 L_LK_58
    s_cmp_ge_u32 s70, 8
    s_cbranch_scc1 L_LK_58
    s_sleep 1
    s_branch L_LW_57
L_LK_58:
    s_setprio 3
    s_cmp_ge_u32 s2, 32
    s_cbranch_scc1 L_CONV
    s_mov_b32 s71, 960000
L_LW_59:
    ds_read_b32 v65, v21 offset:136
    s_waitcnt lgkmcnt(0)
    v_readfirstlane_b32 s70, v65
    s_sub_u32 s71, s71, 1
    s_cbranch_scc1 L_LK_60
    s_cmp_ge_u32 s70, 8
    s_cbranch_scc1 L_LK_60
    s_sleep 1
    s_branch L_LW_59
L_LK_60:
    s_lshr_b32 s70, s2, 3
    s_mul_i32 s70, s70, 12544
    s_mul_i32 s71, s8, 3200
    s_add_u32 s70, s70, s71
    s_mov_b64 exec, 0x1ffffff
    buffer_load_dword v150, v4, s[60:63], s70 offen
    s_mov_b64 exec, -1
    buffer_store_dwordx4 v[44:47], v1, s[44:47], s68 offen sc1
    buffer_store_dwordx4 v[44:47], v1, s[44:47], s68 offen offset:1024 sc1
    s_cmp_eq_u32 s5, 7
    s_cbranch_scc1 L_NOQ_61
    s_lshl_b32 s71, s8, 11
    s_add_u32 m0, s71, 48640
    s_add_u32 s70, s77, 7168
    buffer_load_dwordx4 v56, s[56:59], s77 offen  lds
    s_add_u32 m0, s71, 49664
    s_nop 0
    buffer_load_dwordx4 v57, s[56:59], s70 offen  lds
L_NOQ_61:
    s_setprio 0
    s_waitcnt vmcnt(0)
    s_add_u32 s70, s75, 163840
    s_mov_b64 exec, 1
    buffer_store_dwordx2 v[48:49], v2, s[44:47], s70 offen sc1
    s_mov_b64 exec, 1
    ds_add_u32 v21, v22 offset:128
    s_mov_b64 exec, -1
    s_cmp_eq_u32 s5, 1
    s_cbranch_scc1 L_WS_62
    s_add_u32 m0, s72, 57344
    s_add_u32 s73, s76, 0
    buffer_load_dwordx4 v3, s[60:63], s73 offen lds
L_WS_62:
    s_cmp_eq_u32 s5, 1
    s_cbranch_scc1 L_WS_63
    s_add_u32 m0, s72, 58368
    s_add_u32 s73, s76, 7168
    buffer_load_dwordx4 v3, s[60:63], s73 offen lds
L_WS_63:
    s_waitcnt vmcnt(0)
    s_cmp_eq_u32 s5, 1
    s_cbranch_scc1 L_WS_64
    s_add_u32 m0, s72, 59392
    s_add_u32 s73, s76, 14336
    buffer_load_dwordx4 v3, s[60:63], s73 offen lds
L_WS_64:
    s_cmp_eq_u32 s5, 1
    s_cbranch_scc1 L_WS_65
    s_add_u32 m0, s72, 60416
    s_add_u32 s73, s76, 21504
    buffer_load_dwordx4 v3, s[60:63], s73 offen lds
L_WS_65:
    s_waitcnt vmcnt(0)
    s_cmp_eq_u32 s5, 1
    s_cbranch_scc1 L_WS_66
    s_add_u32 m0, s72, 61440
    s_add_u32 s73, s76, 28672
    buffer_load_dwordx4 v3, s[60:63], s73 offen lds
L_WS_66:
    s_cmp_eq_u32 s5, 1
    s_cbranch_scc1 L_WS_67
    s_add_u32 m0, s72, 62464
    s_add_u32 s73, s76, 35840
    buffer_load_dwordx4 v3, s[60:63], s73 offen lds
L_WS_67:
    s_waitcnt vmcnt(0)
    s_cmp_eq_u32 s5, 1
    s_cbranch_scc1 L_WS_68
    s_add_u32 m0, s72, 63488
    s_add_u32 s73, s76, 43008
    buffer_load_dwordx4 v3, s[60:63], s73 offen lds
L_WS_68:
    s_cmp_eq_u32 s5, 1
    s_cbranch_scc1 L_WS_69
    s_add_u32 m0, s72, 64512
    s_add_u32 s73, s76, 50176
    buffer_load_dwordx4 v3, s[60:63], s73 offen lds
L_WS_69:
    s_waitcnt vmcnt(0)
    s_cmp_eq_u32 s5, 1
    s_cbranch_scc1 L_WS_70
    s_add_u32 m0, s72, 65536
    s_add_u32 s73, s76, 57344
    buffer_load_dwordx4 v3, s[60:63], s73 offen lds
L_WS_70:
    s_cmp_eq_u32 s5, 1
    s_cbranch_scc1 L_WS_71
    s_add_u32 m0, s72, 66560
    s_add_u32 s73, s76, 64512
    buffer_load_dwordx4 v3, s[60:63], s73 offen lds
L_WS_71:
    s_waitcnt vmcnt(0)
    s_cmp_eq_u32 s5, 1
    s_cbranch_scc1 L_WS_72
    s_add_u32 m0, s72, 67584
    s_add_u32 s73, s76, 71680
    buffer_load_dwordx4 v3, s[60:63], s73 offen lds
L_WS_72:
    s_cmp_eq_u32 s5, 1
    s_cbranch_scc1 L_WS_73
    s_add_u32 m0, s72, 68608
    s_add_u32 s73, s76, 78848
    buffer_load_dwordx4 v3, s[60:63], s73 offen lds
L_WS_73:
    s_waitcnt vmcnt(0)
    s_cmp_eq_u32 s5, 1
    s_cbranch_scc1 L_WS_74
    s_add_u32 m0, s72, 69632
    s_add_u32 s73, s76, 86016
    buffer_load_dwordx4 v3, s[60:63], s73 offen lds
L_WS_74:
    s_cmp_eq_u32 s5, 1
    s_cbranch_scc1 L_WS_75
    s_add_u32 m0, s72, 70656
    s_add_u32 s73, s76, 93184
    buffer_load_dwordx4 v3, s[60:63], s73 offen lds
L_WS_75:
    s_waitcnt vmcnt(0)
    s_cmp_eq_u32 s5, 1
    s_cbranch_scc1 L_WS_77
    s_cmp_lg_u32 s8, 3
    s_cbranch_scc1 L_WO_76
    s_add_u32 m0, s72, 71680
    s_add_u32 s73, s76, 100352
    buffer_load_dwordx4 v3, s[60:63], s73 offen lds
L_WO_76:
L_WS_77:
    s_waitcnt vmcnt(0)
    s_mov_b64 exec, 1
    ds_add_u32 v21, v22 offset:92
    s_mov_b64 exec, -1
    s_or_b32 s70, s2, s8
    s_cmp_lg_u32 s70, 0
    s_cbranch_scc1 L_AUXEND
    v_lshrrev_b32 v4, 5, v0
    v_lshlrev_b32 v4, 13, v4
    v_and_b32 v5, 31, v0
    v_lshl_add_u32 v4, v5, 6, v4
    s_mov_b32 s71, 60000
L_EPOLL:
    s_sleep 16
    s_mov_b32 s70, 163840
    buffer_load_dwordx2 v[26:27], v4, s[44:47], s70 offen sc1
    s_mov_b32 s70, 180224
    buffer_load_dwordx2 v[28:29], v4, s[44:47], s70 offen sc1
    s_mov_b32 s70, 196608
    buffer_load_dwordx2 v[30:31], v4, s[44:47], s70 offen sc1
    s_mov_b32 s70, 212992
    buffer_load_dwordx2 v[32:33], v4, s[44:47], s70 offen sc1
    s_waitcnt vmcnt(0)
    v_xor_b32 v26, s6, v26
    v_xor_b32 v27, s7, v27
    v_lshrrev_b32 v27, 4, v27
    v_xor_b32 v28, s6, v28
    v_xor_b32 v29, s7, v29
    v_lshrrev_b32 v29, 4, v29
    v_xor_b32 v30, s6, v30
    v_xor_b32 v31, s7, v31
    v_lshrrev_b32 v31, 4, v31
    v_xor_b32 v32, s6, v32
    v_xor_b32 v33, s7, v33
    v_lshrrev_b32 v33, 4, v33
    v_or3_b32 v26, v26, v27, v28
    v_or3_b32 v26, v26, v29, v30
    v_or3_b32 v26, v26, v31, v32
    v_or_b32 v26, v26, v33
    v_cmp_ne_u32 vcc, 0, v26
    s_nop 3
    s_cbranch_vccz L_EOK
    s_sub_u32 s71, s71, 1
    s_cbranch_scc0 L_EPOLL
L_EOK:
    s_mov_b64 exec, 1
    buffer_store_dwordx2 v[24:25], v2, s[44:47], 0 offen sc1
    s_branch L_AUXEND
L_CONV:
    buffer_load_dwordx4 v[68:71], v11, s[64:67], 0 offen
    buffer_load_dwordx4 v[74:77], v66, s[64:67], 0 offen
    s_mov_b64 exec, 0xffff
    buffer_load_dwordx4 v[80:83], v14, s[64:67], 0 offen
    s_mov_b64 exec, -1
    s_mov_b32 s71, 60000
    s_cmp_lg_u32 s8, 0
    s_cbranch_scc1 L_CWAIT
    s_mov_b32 exec_hi, 0
L_CPOLL:
    s_sleep 12
    buffer_load_dwordx2 v[26:27], v5, s[44:47], s15 offen sc1
    s_waitcnt vmcnt(0)
    v_cmp_ne_u32 vcc, s6, v26
    v_cmp_ne_u32 s[100:101], s7, v27
    s_nop 3
    s_or_b64 exec, vcc, s[100:101]
    s_cbranch_scc0 L_COK
    s_sub_u32 s71, s71, 1
    s_cbranch_scc0 L_CPOLL
L_COK:
    s_mov_b64 exec, 1
    ds_add_u32 v21, v22 offset:88
    s_mov_b64 exec, -1
L_CWAIT:
    s_mov_b32 s71, 960000
L_LW_78:
    ds_read_b32 v65, v21 offset:88
    s_waitcnt lgkmcnt(0)
    v_readfirstlane_b32 s70, v65
    s_sub_u32 s71, s71, 1
    s_cbranch_scc1 L_LK_79
    s_cmp_ge_u32 s70, 1
    s_cbranch_scc1 L_LK_79
    s_sleep 2
    s_branch L_LW_78
L_LK_79:
    buffer_load_dwordx4 v[28:31], v1, s[44:47], s98 offen offset:0 sc1
    buffer_load_dwordx4 v[32:35], v1, s[44:47], s98 offen offset:1024 sc1
    buffer_load_dwordx4 v[36:39], v1, s[44:47], s98 offen offset:2048 sc1
    buffer_load_dwordx4 v[40:43], v1, s[44:47], s98 offen offset:3072 sc1
    s_waitcnt vmcnt(4)
    v_mov_b32_dpp v72, v68 wave_shl:1 row_mask:0xf bank_mask:0xf
    v_mov_b32_dpp v73, v69 wave_shl:1 row_mask:0xf bank_mask:0xf
    s_bitset0_b32 exec_hi, 31
    v_alignbit_b32 v88, v69, v68, 16
    v_alignbit_b32 v96, v70, v69, 16
    v_alignbit_b32 v89, v70, v69, 16
    v_alignbit_b32 v97, v71, v70, 16
    v_alignbit_b32 v90, v71, v70, 16
    v_alignbit_b32 v98, v72, v71, 16
    v_alignbit_b32 v91, v72, v71, 16
    v_alignbit_b32 v99, v73, v72, 16
    ds_write_b128 v10, v[88:91] offset:0
    ds_write2_b32 v151, v69, v70 offset0:0 offset1:1
    ds_write2_b32 v151, v71, v72 offset0:2 offset1:3
    ds_write_b128 v10, v[96:99] offset:8320
    ds_write_b128 v10, v[70:73] offset:12480
    s_mov_b64 exec, -1
    v_mov_b32_dpp v78, v74 wave_shl:1 row_mask:0xf bank_mask:0xf
    v_mov_b32_dpp v79, v75 wave_shl:1 row_mask:0xf bank_mask:0xf
    s_bitset0_b32 exec_hi, 31
    v_alignbit_b32 v88, v75, v74, 16
    v_alignbit_b32 v96, v76, v75, 16
    v_alignbit_b32 v89, v76, v75, 16
    v_alignbit_b32 v97, v77, v76, 16
    v_alignbit_b32 v90, v77, v76, 16
    v_alignbit_b32 v98, v78, v77, 16
    v_alignbit_b32 v91, v78, v77, 16
    v_alignbit_b32 v99, v79, v78, 16
    ds_write_b128 v10, v[88:91] offset:2048
    ds_write2_b32 v152, v75, v76 offset0:0 offset1:1
    ds_write2_b32 v152, v77, v78 offset0:2 offset1:3
    ds_write_b128 v10, v[96:99] offset:10368
    ds_write_b128 v10, v[76:79] offset:14528
    s_mov_b64 exec, -1
    v_mov_b32_dpp v84, v80 wave_shl:1 row_mask:0xf bank_mask:0xf
    v_mov_b32_dpp v85, v81 wave_shl:1 row_mask:0xf bank_mask:0xf
    s_mov_b64 exec, 0x1f1f
    v_alignbit_b32 v88, v81, v80, 16
    v_alignbit_b32 v96, v82, v81, 16
    v_alignbit_b32 v89, v82, v81, 16
    v_alignbit_b32 v97, v83, v82, 16
    v_alignbit_b32 v90, v83, v82, 16
    v_alignbit_b32 v98, v84, v83, 16
    v_alignbit_b32 v91, v84, v83, 16
    v_alignbit_b32 v99, v85, v84, 16
    ds_write_b128 v13, v[88:91] offset:0
    ds_write2_b32 v153, v81, v82 offset0:0 offset1:1
    ds_write2_b32 v153, v83, v84 offset0:2 offset1:3
    ds_write_b128 v13, v[96:99] offset:8320
    ds_write_b128 v13, v[82:85] offset:12480
    s_mov_b64 exec, -1
    ds_write_b128 v23, v[16:19] offset:5120
    ds_write_b128 v23, v[16:19] offset:6400
    s_waitcnt vmcnt(0)
    ds_write_b128 v23, v[28:31] offset:0
    ds_write_b128 v23, v[32:35] offset:1280
    ds_write_b128 v23, v[36:39] offset:2560
    ds_write_b128 v23, v[40:43] offset:3840
    s_waitcnt lgkmcnt(0)
    s_setprio 2
    ds_read_b64 v[96:97], v6 offset:0
    ds_read_b64 v[98:99], v6 offset:8
    ds_read_b128 v[104:107], v8 offset:2560
    ds_read_b128 v[108:111], v8 offset:0
    ds_read_b64 v[100:101], v6 offset:2048
    ds_read_b64 v[102:103], v6 offset:2056
    ds_read_b64 v[112:113], v6 offset:32
    ds_read_b64 v[114:115], v6 offset:40
    ds_read_b128 v[120:123], v8 offset:2592
    ds_read_b128 v[124:127], v8 offset:32
    ds_read_b64 v[116:117], v6 offset:2080
    ds_read_b64 v[118:119], v6 offset:2088
    s_waitcnt lgkmcnt(6)
    v_mfma_f32_32x32x16_bf16 v[64:79], v[96:99], v[104:107], 0
    ds_read_b64 v[128:129], v6 offset:64
    ds_read_b64 v[130:131], v6 offset:72
    v_mfma_f32_32x32x16_bf16 v[80:95], v[96:99], v[108:111], 0
    ds_read_b128 v[136:139], v8 offset:2640
    ds_read_b128 v[140:143], v8 offset:80
    v_mfma_f32_32x32x16_bf16 v[80:95], v[100:103], v[104:107], v[80:95]
    ds_read_b64 v[132:133], v6 offset:2112
    ds_read_b64 v[134:135], v6 offset:2120
    s_waitcnt lgkmcnt(6)
    v_mfma_f32_32x32x16_bf16 v[64:79], v[112:115], v[120:123], v[64:79]
    ds_read_b64 v[96:97], v6 offset:96
    ds_read_b64 v[98:99], v6 offset:104
    v_mfma_f32_32x32x16_bf16 v[80:95], v[112:115], v[124:127], v[80:95]
    ds_read_b128 v[104:107], v8 offset:2672
    ds_read_b128 v[108:111], v8 offset:112
    v_mfma_f32_32x32x16_bf16 v[80:95], v[116:119], v[120:123], v[80:95]
    ds_read_b64 v[100:101], v6 offset:2144
    ds_read_b64 v[102:103], v6 offset:2152
    s_waitcnt lgkmcnt(6)
    v_mfma_f32_32x32x16_bf16 v[64:79], v[128:131], v[136:139], v[64:79]
    ds_read_b64 v[112:113], v6 offset:128
    ds_read_b64 v[114:115], v6 offset:136
    v_mfma_f32_32x32x16_bf16 v[80:95], v[128:131], v[140:143], v[80:95]
    ds_read_b128 v[120:123], v8 offset:2720
    ds_read_b128 v[124:127], v8 offset:160
    v_mfma_f32_32x32x16_bf16 v[80:95], v[132:135], v[136:139], v[80:95]
    ds_read_b64 v[116:117], v6 offset:2176
    ds_read_b64 v[118:119], v6 offset:2184
    s_waitcnt lgkmcnt(6)
    v_mfma_f32_32x32x16_bf16 v[64:79], v[96:99], v[104:107], v[64:79]
    ds_read_b64 v[128:129], v6 offset:160
    ds_read_b64 v[130:131], v6 offset:168
    v_mfma_f32_32x32x16_bf16 v[80:95], v[96:99], v[108:111], v[80:95]
    ds_read_b128 v[136:139], v8 offset:2752
    ds_read_b128 v[140:143], v8 offset:192
    v_mfma_f32_32x32x16_bf16 v[80:95], v[100:103], v[104:107], v[80:95]
    ds_read_b64 v[132:133], v6 offset:2208
    ds_read_b64 v[134:135], v6 offset:2216
    s_waitcnt lgkmcnt(6)
    v_mfma_f32_32x32x16_bf16 v[64:79], v[112:115], v[120:123], v[64:79]
    ds_read_b64 v[96:97], v6 offset:192
    ds_read_b64 v[98:99], v6 offset:200
    v_mfma_f32_32x32x16_bf16 v[80:95], v[112:115], v[124:127], v[80:95]
    ds_read_b128 v[104:107], v8 offset:2800
    ds_read_b128 v[108:111], v8 offset:240
    v_mfma_f32_32x32x16_bf16 v[80:95], v[116:119], v[120:123], v[80:95]
    ds_read_b64 v[100:101], v6 offset:2240
    ds_read_b64 v[102:103], v6 offset:2248
    s_setprio 0
    s_lshr_b32 s70, s2, 3
    s_mul_i32 s70, s70, 12544
    s_mul_i32 s71, s8, 3200
    s_add_u32 s70, s70, s71
    s_mov_b64 exec, 0x1ffffff
    buffer_load_dword v150, v4, s[60:63], s70 offen
    s_mov_b64 exec, -1
    buffer_store_dwordx4 v[44:47], v1, s[44:47], s68 offen sc1
    buffer_store_dwordx4 v[44:47], v1, s[44:47], s68 offen offset:1024 sc1
    s_cmp_eq_u32 s5, 7
    s_cbranch_scc1 L_NOQ_80
    s_lshl_b32 s71, s8, 11
    s_add_u32 m0, s71, 48640
    s_add_u32 s70, s77, 7168
    buffer_load_dwordx4 v56, s[56:59], s77 offen  lds
    s_add_u32 m0, s71, 49664
    s_nop 0
    buffer_load_dwordx4 v57, s[56:59], s70 offen  lds
L_NOQ_80:
    s_waitcnt lgkmcnt(6)
    v_mfma_f32_32x32x16_bf16 v[64:79], v[128:131], v[136:139], v[64:79]
    ds_read_b64 v[112:113], v6 offset:224
    ds_read_b64 v[114:115], v6 offset:232
    v_mfma_f32_32x32x16_bf16 v[80:95], v[128:131], v[140:143], v[80:95]
    ds_read_b128 v[120:123], v8 offset:2832
    ds_read_b128 v[124:127], v8 offset:272
    v_mfma_f32_32x32x16_bf16 v[80:95], v[132:135], v[136:139], v[80:95]
    ds_read_b64 v[116:117], v6 offset:2272
    ds_read_b64 v[118:119], v6 offset:2280
    s_waitcnt lgkmcnt(6)
    v_mfma_f32_32x32x16_bf16 v[64:79], v[96:99], v[104:107], v[64:79]
    ds_read_b64 v[128:129], v6 offset:256
    ds_read_b64 v[130:131], v6 offset:264
    v_mfma_f32_32x32x16_bf16 v[80:95], v[96:99], v[108:111], v[80:95]
    ds_read_b128 v[136:139], v8 offset:2880
    ds_read_b128 v[140:143], v8 offset:320
    v_mfma_f32_32x32x16_bf16 v[80:95], v[100:103], v[104:107], v[80:95]
    ds_read_b64 v[132:133], v6 offset:2304
    ds_read_b64 v[134:135], v6 offset:2312
    s_waitcnt lgkmcnt(6)
    v_mfma_f32_32x32x16_bf16 v[64:79], v[112:115], v[120:123], v[64:79]
    ds_read_b64 v[96:97], v6 offset:288
    ds_read_b64 v[98:99], v6 offset:296
    v_mfma_f32_32x32x16_bf16 v[80:95], v[112:115], v[124:127], v[80:95]
    ds_read_b128 v[104:107], v8 offset:2912
    ds_read_b128 v[108:111], v8 offset:352
    v_mfma_f32_32x32x16_bf16 v[80:95], v[116:119], v[120:123], v[80:95]
    ds_read_b64 v[100:101], v6 offset:2336
    ds_read_b64 v[102:103], v6 offset:2344
    s_waitcnt lgkmcnt(6)
    v_mfma_f32_32x32x16_bf16 v[64:79], v[128:131], v[136:139], v[64:79]
    ds_read_b64 v[112:113], v6 offset:320
    ds_read_b64 v[114:115], v6 offset:328
    v_mfma_f32_32x32x16_bf16 v[80:95], v[128:131], v[140:143], v[80:95]
    ds_read_b128 v[120:123], v8 offset:2960
    ds_read_b128 v[124:127], v8 offset:400
    v_mfma_f32_32x32x16_bf16 v[80:95], v[132:135], v[136:139], v[80:95]
    ds_read_b64 v[116:117], v6 offset:2368
    ds_read_b64 v[118:119], v6 offset:2376
    s_waitcnt lgkmcnt(6)
    v_mfma_f32_32x32x16_bf16 v[64:79], v[96:99], v[104:107], v[64:79]
    ds_read_b64 v[128:129], v6 offset:352
    ds_read_b64 v[130:131], v6 offset:360
    v_mfma_f32_32x32x16_bf16 v[80:95], v[96:99], v[108:111], v[80:95]
    ds_read_b128 v[136:139], v8 offset:2992
    ds_read_b128 v[140:143], v8 offset:432
    v_mfma_f32_32x32x16_bf16 v[80:95], v[100:103], v[104:107], v[80:95]
    ds_read_b64 v[132:133], v6 offset:2400
    ds_read_b64 v[134:135], v6 offset:2408
    s_waitcnt lgkmcnt(6)
    v_mfma_f32_32x32x16_bf16 v[64:79], v[112:115], v[120:123], v[64:79]
    ds_read_b64 v[96:97], v6 offset:384
    ds_read_b64 v[98:99], v6 offset:392
    v_mfma_f32_32x32x16_bf16 v[80:95], v[112:115], v[124:127], v[80:95]
    ds_read_b128 v[104:107], v8 offset:3040
    ds_read_b128 v[108:111], v8 offset:480
    v_mfma_f32_32x32x16_bf16 v[80:95], v[116:119], v[120:123], v[80:95]
    ds_read_b64 v[100:101], v6 offset:2432
    ds_read_b64 v[102:103], v6 offset:2440
    s_waitcnt vmcnt(0)
    s_add_u32 s70, s75, 163840
    s_mov_b64 exec, 1
    buffer_store_dwordx2 v[48:49], v2, s[44:47], s70 offen sc1
    s_mov_b64 exec, 1
    ds_add_u32 v21, v22 offset:128
    s_mov_b64 exec, -1
    s_waitcnt lgkmcnt(7)
    v_mfma_f32_32x32x16_bf16 v[64:79], v[128:131], v[136:139], v[64:79]
    ds_read_b64 v[112:113], v6 offset:416
    ds_read_b64 v[114:115], v6 offset:424
    v_mfma_f32_32x32x16_bf16 v[80:95], v[128:131], v[140:143], v[80:95]
    ds_read_b128 v[120:123], v8 offset:3072
    ds_read_b128 v[124:127], v8 offset:512
    v_mfma_f32_32x32x16_bf16 v[80:95], v[132:135], v[136:139], v[80:95]
    ds_read_b64 v[116:117], v6 offset:2464
    ds_read_b64 v[118:119], v6 offset:2472
    s_waitcnt lgkmcnt(6)
    v_mfma_f32_32x32x16_bf16 v[64:79], v[96:99], v[104:107], v[64:79]
    ds_read_b64 v[128:129], v6 offset:448
    ds_read_b64 v[130:131], v6 offset:456
    v_mfma_f32_32x32x16_bf16 v[80:95], v[96:99], v[108:111], v[80:95]
    ds_read_b128 v[136:139], v8 offset:3120
    ds_read_b128 v[140:143], v8 offset:560
    v_mfma_f32_32x32x16_bf16 v[80:95], v[100:103], v[104:107], v[80:95]
    ds_read_b64 v[132:133], v6 offset:2496
    ds_read_b64 v[134:135], v6 offset:2504
    s_cmp_eq_u32 s5, 1
    s_cbranch_scc1 L_WS_81
    s_add_u32 m0, s72, 57344
    s_add_u32 s73, s76, 0
    buffer_load_dwordx4 v3, s[60:63], s73 offen lds
L_WS_81:
    s_waitcnt lgkmcnt(6)
    v_mfma_f32_32x32x16_bf16 v[64:79], v[112:115], v[120:123], v[64:79]
    ds_read_b64 v[96:97], v6 offset:480
    ds_read_b64 v[98:99], v6 offset:488
    v_mfma_f32_32x32x16_bf16 v[80:95], v[112:115], v[124:127], v[80:95]
    ds_read_b128 v[104:107], v8 offset:3152
    ds_read_b128 v[108:111], v8 offset:592
    v_mfma_f32_32x32x16_bf16 v[80:95], v[116:119], v[120:123], v[80:95]
    ds_read_b64 v[100:101], v6 offset:2528
    ds_read_b64 v[102:103], v6 offset:2536
    s_cmp_eq_u32 s5, 1
    s_cbranch_scc1 L_WS_82
    s_add_u32 m0, s72, 58368
    s_add_u32 s73, s76, 7168
    buffer_load_dwordx4 v3, s[60:63], s73 offen lds
L_WS_82:
    s_waitcnt lgkmcnt(6)
    v_mfma_f32_32x32x16_bf16 v[64:79], v[128:131], v[136:139], v[64:79]
    ds_read_b64 v[112:113], v6 offset:512
    ds_read_b64 v[114:115], v6 offset:520
    v_mfma_f32_32x32x16_bf16 v[80:95], v[128:131], v[140:143], v[80:95]
    ds_read_b128 v[120:123], v8 offset:3200
    ds_read_b128 v[124:127], v8 offset:640
    v_mfma_f32_32x32x16_bf16 v[80:95], v[132:135], v[136:139], v[80:95]
    ds_read_b64 v[116:117], v6 offset:2560
    ds_read_b64 v[118:119], v6 offset:2568
    s_cmp_eq_u32 s5, 1
    s_cbranch_scc1 L_WS_83
    s_add_u32 m0, s72, 59392
    s_add_u32 s73, s76, 14336
    buffer_load_dwordx4 v3, s[60:63], s73 offen lds
L_WS_83:
    s_waitcnt lgkmcnt(6)
    v_mfma_f32_32x32x16_bf16 v[64:79], v[96:99], v[104:107], v[64:79]
    ds_read_b64 v[128:129], v6 offset:544
    ds_read_b64 v[130:131], v6 offset:552
    v_mfma_f32_32x32x16_bf16 v[80:95], v[96:99], v[108:111], v[80:95]
    ds_read_b128 v[136:139], v8 offset:3232
    ds_read_b128 v[140:143], v8 offset:672
    v_mfma_f32_32x32x16_bf16 v[80:95], v[100:103], v[104:107], v[80:95]
    ds_read_b64 v[132:133], v6 offset:2592
    ds_read_b64 v[134:135], v6 offset:2600
    s_cmp_eq_u32 s5, 1
    s_cbranch_scc1 L_WS_84
    s_add_u32 m0, s72, 60416
    s_add_u32 s73, s76, 21504
    buffer_load_dwordx4 v3, s[60:63], s73 offen lds
L_WS_84:
    s_waitcnt lgkmcnt(6)
    v_mfma_f32_32x32x16_bf16 v[64:79], v[112:115], v[120:123], v[64:79]
    ds_read_b64 v[96:97], v6 offset:576
    ds_read_b64 v[98:99], v6 offset:584
    v_mfma_f32_32x32x16_bf16 v[80:95], v[112:115], v[124:127], v[80:95]
    ds_read_b128 v[104:107], v8 offset:3280
    ds_read_b128 v[108:111], v8 offset:720
    v_mfma_f32_32x32x16_bf16 v[80:95], v[116:119], v[120:123], v[80:95]
    ds_read_b64 v[100:101], v6 offset:2624
    ds_read_b64 v[102:103], v6 offset:2632
    s_cmp_eq_u32 s5, 1
    s_cbranch_scc1 L_WS_85
    s_add_u32 m0, s72, 61440
    s_add_u32 s73, s76, 28672
    buffer_load_dwordx4 v3, s[60:63], s73 offen lds
L_WS_85:
    s_waitcnt lgkmcnt(6)
    v_mfma_f32_32x32x16_bf16 v[64:79], v[128:131], v[136:139], v[64:79]
    ds_read_b64 v[112:113], v6 offset:608
    ds_read_b64 v[114:115], v6 offset:616
    v_mfma_f32_32x32x16_bf16 v[80:95], v[128:131], v[140:143], v[80:95]
    ds_read_b128 v[120:123], v8 offset:3312
    ds_read_b128 v[124:127], v8 offset:752
    v_mfma_f32_32x32x16_bf16 v[80:95], v[132:135], v[136:139], v[80:95]
    ds_read_b64 v[116:117], v6 offset:2656
    ds_read_b64 v[118:119], v6 offset:2664
    s_cmp_eq_u32 s5, 1
    s_cbranch_scc1 L_WS_86
    s_add_u32 m0, s72, 62464
    s_add_u32 s73, s76, 35840
    buffer_load_dwordx4 v3, s[60:63], s73 offen lds
L_WS_86:
    s_waitcnt lgkmcnt(6)
    v_mfma_f32_32x32x16_bf16 v[64:79], v[96:99], v[104:107], v[64:79]
    ds_read_b64 v[128:129], v6 offset:640
    ds_read_b64 v[130:131], v6 offset:648
    v_mfma_f32_32x32x16_bf16 v[80:95], v[96:99], v[108:111], v[80:95]
    ds_read_b128 v[136:139], v8 offset:3360
    ds_read_b128 v[140:143], v8 offset:800
    v_mfma_f32_32x32x16_bf16 v[80:95], v[100:103], v[104:107], v[80:95]
    ds_read_b64 v[132:133], v6 offset:2688
    ds_read_b64 v[134:135], v6 offset:2696
    s_cmp_eq_u32 s5, 1
    s_cbranch_scc1 L_WS_87
    s_add_u32 m0, s72, 63488
    s_add_u32 s73, s76, 43008
    buffer_load_dwordx4 v3, s[60:63], s73 offen lds
L_WS_87:
    s_waitcnt lgkmcnt(6)
    v_mfma_f32_32x32x16_bf16 v[64:79], v[112:115], v[120:123], v[64:79]
    ds_read_b64 v[96:97], v6 offset:672
    ds_read_b64 v[98:99], v6 offset:680
    v_mfma_f32_32x32x16_bf16 v[80:95], v[112:115], v[124:127], v[80:95]
    ds_read_b128 v[104:107], v8 offset:3392
    ds_read_b128 v[108:111], v8 offset:832
    v_mfma_f32_32x32x16_bf16 v[80:95], v[116:119], v[120:123], v[80:95]
    ds_read_b64 v[100:101], v6 offset:2720
    ds_read_b64 v[102:103], v6 offset:2728
    s_waitcnt lgkmcnt(6)
    v_mfma_f32_32x32x16_bf16 v[64:79], v[128:131], v[136:139], v[64:79]
    ds_read_b64 v[112:113], v6 offset:704
    ds_read_b64 v[114:115], v6 offset:712
    v_mfma_f32_32x32x16_bf16 v[80:95], v[128:131], v[140:143], v[80:95]
    ds_read_b128 v[120:123], v8 offset:3440
    ds_read_b128 v[124:127], v8 offset:880
    v_mfma_f32_32x32x16_bf16 v[80:95], v[132:135], v[136:139], v[80:95]
    ds_read_b64 v[116:117], v6 offset:2752
    ds_read_b64 v[118:119], v6 offset:2760
    s_cmp_eq_u32 s5, 1
    s_cbranch_scc1 L_WS_88
    s_add_u32 m0, s72, 64512
    s_add_u32 s73, s76, 50176
    buffer_load_dwordx4 v3, s[60:63], s73 offen lds
L_WS_88:
    s_waitcnt lgkmcnt(6)
    v_mfma_f32_32x32x16_bf16 v[64:79], v[96:99], v[104:107], v[64:79]
    ds_read_b64 v[128:129], v6 offset:736
    ds_read_b64 v[130:131], v6 offset:744
    v_mfma_f32_32x32x16_bf16 v[80:95], v[96:99], v[108:111], v[80:95]
    ds_read_b128 v[136:139], v8 offset:3472
    ds_read_b128 v[140:143], v8 offset:912
    v_mfma_f32_32x32x16_bf16 v[80:95], v[100:103], v[104:107], v[80:95]
    ds_read_b64 v[132:133], v6 offset:2784
    ds_read_b64 v[134:135], v6 offset:2792
    s_cmp_eq_u32 s5, 1
    s_cbranch_scc1 L_WS_89
    s_add_u32 m0, s72, 65536
    s_add_u32 s73, s76, 57344
    buffer_load_dwordx4 v3, s[60:63], s73 offen lds
L_WS_89:
    s_waitcnt lgkmcnt(6)
    v_mfma_f32_32x32x16_bf16 v[64:79], v[112:115], v[120:123], v[64:79]
    ds_read_b64 v[96:97], v6 offset:768
    ds_read_b64 v[98:99], v6 offset:776
    v_mfma_f32_32x32x16_bf16 v[80:95], v[112:115], v[124:127], v[80:95]
    ds_read_b128 v[104:107], v8 offset:3520
    ds_read_b128 v[108:111], v8 offset:960
    v_mfma_f32_32x32x16_bf16 v[80:95], v[116:119], v[120:123], v[80:95]
    ds_read_b64 v[100:101], v6 offset:2816
    ds_read_b64 v[102:103], v6 offset:2824
    s_cmp_eq_u32 s5, 1
    s_cbranch_scc1 L_WS_90
    s_add_u32 m0, s72, 66560
    s_add_u32 s73, s76, 64512
    buffer_load_dwordx4 v3, s[60:63], s73 offen lds
L_WS_90:
    s_waitcnt lgkmcnt(6)
    v_mfma_f32_32x32x16_bf16 v[64:79], v[128:131], v[136:139], v[64:79]
    ds_read_b64 v[112:113], v6 offset:800
    ds_read_b64 v[114:115], v6 offset:808
    v_mfma_f32_32x32x16_bf16 v[80:95], v[128:131], v[140:143], v[80:95]
    ds_read_b128 v[120:123], v8 offset:3552
    ds_read_b128 v[124:127], v8 offset:992
    v_mfma_f32_32x32x16_bf16 v[80:95], v[132:135], v[136:139], v[80:95]
    ds_read_b64 v[116:117], v6 offset:2848
    ds_read_b64 v[118:119], v6 offset:2856
    s_cmp_eq_u32 s5, 1
    s_cbranch_scc1 L_WS_91
    s_add_u32 m0, s72, 67584
    s_add_u32 s73, s76, 71680
    buffer_load_dwordx4 v3, s[60:63], s73 offen lds
L_WS_91:
    s_waitcnt lgkmcnt(6)
    v_mfma_f32_32x32x16_bf16 v[64:79], v[96:99], v[104:107], v[64:79]
    ds_read_b64 v[128:129], v6 offset:832
    ds_read_b64 v[130:131], v6 offset:840
    v_mfma_f32_32x32x16_bf16 v[80:95], v[96:99], v[108:111], v[80:95]
    ds_read_b128 v[136:139], v8 offset:3600
    ds_read_b128 v[140:143], v8 offset:1040
    v_mfma_f32_32x32x16_bf16 v[80:95], v[100:103], v[104:107], v[80:95]
    ds_read_b64 v[132:133], v6 offset:2880
    ds_read_b64 v[134:135], v6 offset:2888
    s_cmp_eq_u32 s5, 1
    s_cbranch_scc1 L_WS_92
    s_add_u32 m0, s72, 68608
    s_add_u32 s73, s76, 78848
    buffer_load_dwordx4 v3, s[60:63], s73 offen lds
L_WS_92:
    s_waitcnt lgkmcnt(6)
    v_mfma_f32_32x32x16_bf16 v[64:79], v[112:115], v[120:123], v[64:79]
    ds_read_b64 v[96:97], v6 offset:864
    ds_read_b64 v[98:99], v6 offset:872
    v_mfma_f32_32x32x16_bf16 v[80:95], v[112:115], v[124:127], v[80:95]
    ds_read_b128 v[104:107], v8 offset:3632
    ds_read_b128 v[108:111], v8 offset:1072
    v_mfma_f32_32x32x16_bf16 v[80:95], v[116:119], v[120:123], v[80:95]
    ds_read_b64 v[100:101], v6 offset:2912
    ds_read_b64 v[102:103], v6 offset:2920
    s_cmp_eq_u32 s5, 1
    s_cbranch_scc1 L_WS_93
    s_add_u32 m0, s72, 69632
    s_add_u32 s73, s76, 86016
    buffer_load_dwordx4 v3, s[60:63], s73 offen lds
L_WS_93:
    s_waitcnt lgkmcnt(6)
    v_mfma_f32_32x32x16_bf16 v[64:79], v[128:131], v[136:139], v[64:79]
    ds_read_b64 v[112:113], v6 offset:896
    ds_read_b64 v[114:115], v6 offset:904
    v_mfma_f32_32x32x16_bf16 v[80:95], v[128:131], v[140:143], v[80:95]
    ds_read_b128 v[120:123], v8 offset:3680
    ds_read_b128 v[124:127], v8 offset:1120
    v_mfma_f32_32x32x16_bf16 v[80:95], v[132:135], v[136:139], v[80:95]
    ds_read_b64 v[116:117], v6 offset:2944
    ds_read_b64 v[118:119], v6 offset:2952
    s_cmp_eq_u32 s5, 1
    s_cbranch_scc1 L_WS_94
    s_add_u32 m0, s72, 70656
    s_add_u32 s73, s76, 93184
    buffer_load_dwordx4 v3, s[60:63], s73 offen lds
L_WS_94:
    s_waitcnt lgkmcnt(6)
    v_mfma_f32_32x32x16_bf16 v[64:79], v[96:99], v[104:107], v[64:79]
    ds_read_b64 v[128:129], v6 offset:928
    ds_read_b64 v[130:131], v6 offset:936
    v_mfma_f32_32x32x16_bf16 v[80:95], v[96:99], v[108:111], v[80:95]
    ds_read_b128 v[136:139], v8 offset:3712
    ds_read_b128 v[140:143], v8 offset:1152
    v_mfma_f32_32x32x16_bf16 v[80:95], v[100:103], v[104:107], v[80:95]
    ds_read_b64 v[132:133], v6 offset:2976
    ds_read_b64 v[134:135], v6 offset:2984
    s_waitcnt lgkmcnt(6)
    v_mfma_f32_32x32x16_bf16 v[64:79], v[112:115], v[120:123], v[64:79]
    ds_read_b64 v[96:97], v6 offset:960
    ds_read_b64 v[98:99], v6 offset:968
    v_mfma_f32_32x32x16_bf16 v[80:95], v[112:115], v[124:127], v[80:95]
    ds_read_b128 v[104:107], v8 offset:3760
    ds_read_b128 v[108:111], v8 offset:1200
    v_mfma_f32_32x32x16_bf16 v[80:95], v[116:119], v[120:123], v[80:95]
    ds_read_b64 v[100:101], v6 offset:3008
    ds_read_b64 v[102:103], v6 offset:3016
    s_cmp_eq_u32 s5, 1
    s_cbranch_scc1 L_WS_96
    s_cmp_lg_u32 s8, 3
    s_cbranch_scc1 L_WO_95
    s_add_u32 m0, s72, 71680
    s_add_u32 s73, s76, 100352
    buffer_load_dwordx4 v3, s[60:63], s73 offen lds
L_WO_95:
L_WS_96:
    s_waitcnt lgkmcnt(6)
    v_mfma_f32_32x32x16_bf16 v[64:79], v[128:131], v[136:139], v[64:79]
    ds_read_b64 v[112:113], v6 offset:992
    ds_read_b64 v[114:115], v6 offset:1000
    v_mfma_f32_32x32x16_bf16 v[80:95], v[128:131], v[140:143], v[80:95]
    ds_read_b128 v[120:123], v8 offset:3792
    ds_read_b128 v[124:127], v8 offset:1232
    v_mfma_f32_32x32x16_bf16 v[80:95], v[132:135], v[136:139], v[80:95]
    ds_read_b64 v[116:117], v6 offset:3040
    ds_read_b64 v[118:119], v6 offset:3048
    s_waitcnt lgkmcnt(6)
    v_mfma_f32_32x32x16_bf16 v[64:79], v[96:99], v[104:107], v[64:79]
    v_mfma_f32_32x32x16_bf16 v[80:95], v[96:99], v[108:111], v[80:95]
    v_mfma_f32_32x32x16_bf16 v[80:95], v[100:103], v[104:107], v[80:95]
    s_waitcnt vmcnt(0)
    s_mov_b64 exec, 1
    ds_add_u32 v21, v22 offset:92
    s_mov_b64 exec, -1
    s_waitcnt lgkmcnt(0)
    v_mfma_f32_32x32x16_bf16 v[64:79], v[112:115], v[120:123], v[64:79]
    v_mfma_f32_32x32x16_bf16 v[80:95], v[112:115], v[124:127], v[80:95]
    v_mfma_f32_32x32x16_bf16 v[80:95], v[116:119], v[120:123], v[80:95]
    s_setprio 3
    s_nop 7
    s_cmp_eq_u32 s10, 0
    s_cbranch_scc1 L_CX0
    ds_write_b128 v145, v[64:67] offset:0
    ds_write_b128 v145, v[68:71] offset:1024
    ds_write_b128 v145, v[72:75] offset:2048
    ds_write_b128 v145, v[76:79] offset:3072
    s_branch L_CX1
L_CX0:
    s_nop 0
    ds_write_b128 v145, v[80:83] offset:0
    ds_write_b128 v145, v[84:87] offset:1024
    ds_write_b128 v145, v[88:91] offset:2048
    ds_write_b128 v145, v[92:95] offset:3072
L_CX1:
    ds_write_b32 v147, v22
    s_mov_b32 s71, 960000
L_CXP:
    ds_read_b32 v10, v148
    s_waitcnt lgkmcnt(0)
    v_readfirstlane_b32 s70, v10
    s_sub_u32 s71, s71, 1
    s_cbranch_scc1 L_CXOK
    s_cmp_lg_u32 s70, 0
    s_cbranch_scc1 L_CXOK
    s_sleep 1
    s_branch L_CXP
L_CXOK:
    ds_read_b128 v[96:99], v146 offset:0
    ds_read_b128 v[100:103], v146 offset:1024
    ds_read_b128 v[104:107], v146 offset:2048
    ds_read_b128 v[108:111], v146 offset:3072
    s_cmp_eq_u32 s10, 0
    s_waitcnt lgkmcnt(0)
    s_cbranch_scc1 L_CY0
    v_pk_add_f32 v[64:65], v[80:81], v[96:97]
    v_pk_add_f32 v[66:67], v[82:83], v[98:99]
    v_pk_add_f32 v[68:69], v[84:85], v[100:101]
    v_pk_add_f32 v[70:71], v[86:87], v[102:103]
    v_pk_add_f32 v[72:73], v[88:89], v[104:105]
    v_pk_add_f32 v[74:75], v[90:91], v[106:107]
    v_pk_add_f32 v[76:77], v[92:93], v[108:109]
    v_pk_add_f32 v[78:79], v[94:95], v[110:111]
    s_branch L_CY1
L_CY0:
    v_pk_add_f32 v[64:65], v[64:65], v[96:97]
    v_pk_add_f32 v[66:67], v[66:67], v[98:99]
    v_pk_add_f32 v[68:69], v[68:69], v[100:101]
    v_pk_add_f32 v[70:71], v[70:71], v[102:103]
    v_pk_add_f32 v[72:73], v[72:73], v[104:105]
    v_pk_add_f32 v[74:75], v[74:75], v[106:107]
    v_pk_add_f32 v[76:77], v[76:77], v[108:109]
    v_pk_add_f32 v[78:79], v[78:79], v[110:111]
L_CY1:
    v_cvt_pk_bf16_f32 v40, v64, v65
    v_cvt_pk_bf16_f32 v41, v66, v67
    v_cvt_pk_bf16_f32 v42, v68, v69
    v_cvt_pk_bf16_f32 v43, v70, v71
    v_cvt_pk_bf16_f32 v44, v72, v73
    v_cvt_pk_bf16_f32 v45, v74, v75
    v_cvt_pk_bf16_f32 v46, v76, v77
    v_cvt_pk_bf16_f32 v47, v78, v79
    v_min_u32 v40, -2, v40
    v_min_u32 v41, -2, v41
    v_min_u32 v42, -2, v42
    v_min_u32 v43, -2, v43
    v_min_u32 v44, -2, v44
    v_min_u32 v45, -2, v45
    v_min_u32 v46, -2, v46
    v_min_u32 v47, -2, v47
    s_nop 1
    v_permlane32_swap_b32 v40, v42
    v_permlane32_swap_b32 v41, v43
    v_permlane32_swap_b32 v44, v46
    v_permlane32_swap_b32 v45, v47
    s_nop 1
    v_permlane16_swap_b32 v40, v44
    v_permlane16_swap_b32 v41, v45
    v_permlane16_swap_b32 v42, v46
    v_permlane16_swap_b32 v43, v47
    buffer_store_dwordx4 v[40:43], v149, s[44:47], s14 offen sc1
    buffer_store_dwordx4 v[44:47], v149, s[44:47], s14 offen offset:1024 sc1
L_AUXEND:
L_END:
    s_endpgm
.section .rodata,"a"
.p2align 6
.amdhsa_kernel concat_heads__ssm_conv_h3__grouped_kv_mqa__prompt_kernel
.amdhsa_next_free_vgpr 168
.amdhsa_next_free_sgpr 102
.amdhsa_accum_offset 168
.amdhsa_group_segment_fixed_size 0
.amdhsa_kernarg_size 112
.amdhsa_user_sgpr_count 2
.amdhsa_user_sgpr_kernarg_segment_ptr 1
.amdhsa_system_sgpr_workgroup_id_x 1
.end_amdhsa_kernel
```
